```python
import torch

def _softmax(x, axis=-1):
    return torch.softmax(x, dim=axis)
def _gelu(x):
    return torch.nn.functional.gelu(x, approximate="tanh")
def _silu(x):
    return torch.nn.functional.silu(x)
def _sigmoid(x):
    return torch.sigmoid(x)
def _layernorm(x, axis=-1, eps=1e-5):
    m = x.mean(dim=axis, keepdim=True)
    v = x.var(dim=axis, keepdim=True, unbiased=False)
    return (x - m) / torch.sqrt(v + eps)
def _scatter_add(tgt, idx, src, axis=0):
    return tgt.clone().index_add_(axis, idx, src)
def _segment_sum(src, seg, n):
    out = torch.zeros((n,) + src.shape[1:], dtype=src.dtype)
    return out.index_add_(0, seg, src)
def _pad(x, pw):
    flat = tuple(v for pair in reversed(pw) for v in pair)
    return torch.nn.functional.pad(x, flat)

kernel_name = 'parallel_sum__sliding_block__swiglu_ffn__prompt'

def setup_inputs():

    _w = (lambda a: (lambda t: t.to(torch.bfloat16) if t.is_floating_point() else t)(torch.as_tensor(a)))
    def _A_setup():
        B, S, D = 1, 2048, 512
        return {
            "x": _w((lambda *s: torch.randn(*s, dtype=torch.bfloat16) * 0.05)(B, S, D)),
            "wqkv": _w((lambda *s: torch.randn(*s, dtype=torch.bfloat16) * 0.05)(D, 3 * D)),
            "wo": _w((lambda *s: torch.randn(*s, dtype=torch.bfloat16) * 0.1)(D, D)),
        }
    _A_in = _A_setup()

    def _B_setup():
        B, S, D, F = 1, 2048, 512, 1792
        return {
            "x": _w((lambda *s: torch.randn(*s, dtype=torch.bfloat16) * 0.05)(B, S, D)),
            "w_gate": _w((lambda *s: torch.randn(*s, dtype=torch.bfloat16) * 0.05)(D, F)),
            "w_up": _w((lambda *s: torch.randn(*s, dtype=torch.bfloat16) * 0.05)(D, F)),
            "w_down": _w((lambda *s: torch.randn(*s, dtype=torch.bfloat16) * 0.05)(F, D)),
        }
    _B_in = _B_setup()

    return {
        "A_x": _A_in["x"],
        "A_wqkv": _A_in["wqkv"],
        "A_wo": _A_in["wo"],
        "B_x": _B_in["x"],
        "B_w_gate": _B_in["w_gate"],
        "B_w_up": _B_in["w_up"],
        "B_w_down": _B_in["w_down"],
    }

def reference(A_x, A_wqkv, A_wo, B_x, B_w_gate, B_w_up, B_w_down):
    def _A_ref(x, wqkv, wo):
        B, S, D = x.shape
        H = 32; Dh = D // H; W = 256
        qkv = (lambda x, *d: x.permute(*d))((x @ wqkv).reshape(B, S, 3, H, Dh), 2, 0, 3, 1, 4)
        q, k, v = qkv[0], qkv[1], qkv[2]
        scores = torch.einsum("bhqd,bhkd->bhqk", q, k) * (Dh ** -0.5)
        idx = torch.arange(S)
        mask = (idx[:, None] - idx[None, :] >= 0) & (idx[:, None] - idx[None, :] < W)
        scores = torch.where(mask[None, None], scores, -1e9)
        p = _softmax(scores, axis=-1)
        o = torch.einsum("bhqk,bhkd->bhqd", p, v)
        return (lambda x, *d: x.permute(*d))(o, 0, 2, 1, 3).reshape(B, S, D) @ wo

    def _B_ref(x, w_gate, w_up, w_down):
        g = _silu(x @ w_gate)
        u = x @ w_up
        return (g * u) @ w_down

    x = A_x
    xn = _layernorm(x, axis=-1)
    return x + _A_ref(xn, A_wqkv, A_wo) + _B_ref(xn, B_w_gate, B_w_up, B_w_down)
```

```asm
; @launch grid=(256,1,1) block=(256,1,1) lds=163840
.amdgcn_target "amdgcn-amd-amdhsa--gfx950"
.text
.globl parallel_sum__sliding_block__swiglu_ffn__prompt_kernel
.p2align 8
.type parallel_sum__sliding_block__swiglu_ffn__prompt_kernel,@function
parallel_sum__sliding_block__swiglu_ffn__prompt_kernel:
    s_load_dwordx16 s[4:19], s[0:1], 0
    s_load_dwordx4 s[20:23], s[0:1], 64
    s_cmp_ge_u32 s2, 256
    s_cbranch_scc1 L_end
    s_getpc_b64 s[72:73]
L_pc:
    v_lshlrev_b32 v27, 4, v0
    global_load_dword v54, v27, s[72:73]
    v_lshrrev_b32 v23, 6, v0
    v_and_b32 v24, 63, v0
    v_readfirstlane_b32 s3, v23
    s_and_b32 s95, s2, 7
    s_lshr_b32 s97, s2, 3
    s_and_b32 s79, s95, 1
    s_and_b32 s82, s97, 7
    s_lshl3_add_u32 s79, s79, s82
    s_lshr_b32 s97, s97, 3
    s_lshr_b32 s80, s95, 1
    s_lshl2_add_u32 s80, s80, s97
    s_lshl2_add_u32 s81, s95, s97
    v_lshrrev_b32 v25, 3, v24
    v_and_b32 v26, 7, v24
    v_lshrrev_b32 v27, 4, v24
    v_xor_b32 v27, v27, v26
    v_lshlrev_b32 v27, 4, v27
    v_lshl_add_u32 v32, v25, 10, v27
    v_xor_b32 v33, 64, v32
    v_add_u32 v33, 7168, v33
    v_add_u32 v34, 14336, v32
    v_add_u32 v35, 14336, v33
    s_lshl1_add_u32 s98, s97, s82
    s_add_u32 s64, s98, 0
    s_and_b32 s64, s64, 7
    s_lshl_b32 s64, s64, 6
    s_add_u32 s65, s98, 1
    s_and_b32 s65, s65, 7
    s_lshl_b32 s65, s65, 6
    s_add_u32 s66, s98, 2
    s_and_b32 s66, s66, 7
    s_lshl_b32 s66, s66, 6
    s_add_u32 s67, s98, 3
    s_and_b32 s67, s67, 7
    s_lshl_b32 s67, s67, 6
    s_add_u32 s68, s98, 4
    s_and_b32 s68, s68, 7
    s_lshl_b32 s68, s68, 6
    s_add_u32 s69, s98, 5
    s_and_b32 s69, s69, 7
    s_lshl_b32 s69, s69, 6
    s_add_u32 s70, s98, 6
    s_and_b32 s70, s70, 7
    s_lshl_b32 s70, s70, 6
    s_add_u32 s71, s98, 7
    s_and_b32 s71, s71, 7
    s_lshl_b32 s71, s71, 6
    s_lshl2_add_u32 s88, s79, s3
    s_lshl_b32 s95, s88, 15
    s_lshl_b32 s92, s3, 14
    s_add_u32 s92, s92, 81920
    s_lshl_b32 s101, s3, 12
    v_bfe_u32 v27, v25, 1, 1
    v_lshlrev_b32 v27, 1, v27
    v_xor_b32 v27, v27, v26
    v_lshlrev_b32 v27, 4, v27
    s_lshl_b32 s98, s3, 4
    v_add_u32 v28, s98, v25
    s_lshr_b32 s89, s80, 2
    s_and_b32 s99, s80, 3
    s_mul_i32 s90, s89, 7
    s_lshl1_add_u32 s90, s99, s90
    s_sub_u32 s76, s90, 1
    s_cmp_eq_u32 s80, 4
    s_cselect_b32 s90, 9, s90
    s_cmp_eq_u32 s80, 5
    s_cselect_b32 s90, 7, s90
    s_add_u32 s77, s89, 4
    s_cmp_eq_u32 s89, 0
    s_cselect_b32 s77, 3, s77
    s_cmp_eq_u32 s89, 3
    s_cselect_b32 s89, 4, s89
    s_cmp_eq_u32 s99, 0
    s_movk_i32 s86, 3584
    s_cselect_b32 s86, 3072, s86
    v_mul_lo_u32 v11, v28, s86
    s_lshl_b32 s98, s86, 3
    s_sub_u32 s98, s98, 1024
    v_add_u32 v11, v11, v27
    v_add_u32 v11, 3072, v11
    v_add_u32 v12, s98, v11
    v_xor_b32 v13, 64, v11
    v_xor_b32 v14, 64, v12
    v_subrev_u32 v13, 2048, v13
    v_subrev_u32 v14, 2048, v14
    s_add_u32 s98, s89, 0
    s_and_b32 s98, s98, 7
    s_lshl_b32 s98, s98, 7
    s_add_u32 s98, s98, 1024
    s_lshl_b32 s96, s76, 7
    s_cmp_eq_u32 s99, 0
    s_cselect_b32 s98, s98, s96
    s_cselect_b32 s96, 1024, 0
    s_add_u32 s87, s96, s98
    s_waitcnt lgkmcnt(0)
    s_mov_b32 s24, s4
    s_mov_b32 s25, s5
    s_mov_b32 s26, 2097152
    s_mov_b32 s27, 0x20000
    s_mov_b32 s4, s95
    s_mov_b32 s5, s92
    v_mov_b32 v20, 131072
    s_lshl4_add_u32 s96, s79, s80
    s_lshl2_add_u32 s96, s96, s3
    s_lshl_b32 s74, s96, 11
    v_lshlrev_b32 v238, 5, v24
    s_add_u32 m0, s5, 0
    s_lshl1_add_u32 s92, s64, s4
    buffer_load_dwordx4 v32, s[24:27], s92 offen offset:0  lds
    buffer_load_dwordx4 v33, s[24:27], s92 offen offset:1024  lds
    buffer_load_dwordx4 v34, s[24:27], s92 offen offset:2048  lds
    buffer_load_dwordx4 v35, s[24:27], s92 offen offset:3072  lds
    s_cmp_eq_u32 s99, 0
    s_cselect_b64 s[28:29], s[6:7], s[12:13]
    s_cselect_b64 s[32:33], s[6:7], s[14:15]
    s_lshl_b32 s30, s86, 9
    s_add_u32 s30, s30, 3072
    s_mov_b32 s34, s30
    s_sub_u32 s28, s28, 3072
    s_subb_u32 s29, s29, 0
    s_sub_u32 s32, s32, 3072
    s_subb_u32 s33, s33, 0
    s_mov_b32 s31, 0x20000
    s_mov_b32 s35, 0x20000
    v_add_u32 v11, s98, v11
    v_add_u32 v12, s98, v12
    v_add_u32 v13, s87, v13
    v_add_u32 v14, s87, v14
    s_add_u32 m0, s101, 0
    s_mul_i32 s91, s64, s86
    buffer_load_dwordx4 v11, s[28:31], s91 offen offset:0  lds
    buffer_load_dwordx4 v12, s[28:31], s91 offen offset:1024  lds
    buffer_load_dwordx4 v13, s[32:35], s91 offen offset:2048  lds
    buffer_load_dwordx4 v14, s[32:35], s91 offen offset:3072  lds
    global_load_dword v20, v20, s[22:23]
    buffer_load_dwordx4 v[240:243], v238, s[24:27], s74 offen
    buffer_load_dwordx4 v[244:247], v238, s[24:27], s74 offen offset:16
    s_lshl_b32 s96, s82, 12
    s_add_u32 s96, s96, 4096
    v_lshl_add_u32 v236, v0, 4, s96
    v_min_u32 v236, L_end-L_pc, v236
    global_load_dword v54, v236, s[72:73]
    v_and_b32 v29, 31, v24
    v_lshrrev_b32 v30, 5, v24
    v_bfe_u32 v228, v29, 1, 3
    v_xor_b32 v228, v228, v30
    v_lshlrev_b32 v228, 4, v228
    v_lshl_add_u32 v228, v29, 7, v228
    s_and_b32 s96, s3, 2
    s_lshl_b32 s96, s96, 14
    s_add_u32 s96, s96, 81920
    v_add_u32 v36, s96, v228
    v_xor_b32 v37, 32, v36
    v_xor_b32 v38, 64, v36
    v_xor_b32 v39, 96, v36
    v_lshlrev_b32 v1, 4, v24
    v_bfe_u32 v224, v24, 4, 1
    v_bfe_u32 v225, v24, 2, 2
    v_and_b32 v226, 3, v24
    v_bfe_u32 v227, v24, 3, 1
    v_lshlrev_b32 v228, 1, v224
    v_xor_b32 v228, v228, v227
    v_lshlrev_b32 v228, 5, v228
    v_lshl_add_u32 v228, v226, 3, v228
    v_lshl_add_u32 v228, v225, 7, v228
    v_lshl_add_u32 v228, v30, 10, v228
    v_lshl_add_u32 v228, v224, 11, v228
    s_and_b32 s96, s3, 1
    s_lshr_b32 s97, s3, 1
    s_lshl1_add_u32 s96, s96, s97
    s_lshl_b32 s96, s96, 5
    v_xor_b32 v5, s96, v228
    v_xor_b32 v6, 32, v5
    v_mov_b32 v64, 0x3f803f80
    v_xor_b32 v228, v224, v24
    v_and_b32 v228, 1, v228
    v_cmp_eq_u32 vcc, 0, v228
    s_nop 1
    v_cndmask_b32 v112, 0, v64, vcc
    v_cndmask_b32 v113, 0, v64, vcc
    v_cndmask_b32 v114, 0, v64, vcc
    v_cndmask_b32 v115, 0, v64, vcc
    s_add_u32 m0, s5, 4096
    s_lshl1_add_u32 s92, s65, s4
    buffer_load_dwordx4 v32, s[24:27], s92 offen offset:0  lds
    buffer_load_dwordx4 v33, s[24:27], s92 offen offset:1024  lds
    buffer_load_dwordx4 v34, s[24:27], s92 offen offset:2048  lds
    buffer_load_dwordx4 v35, s[24:27], s92 offen offset:3072  lds
    s_add_u32 m0, s101, 16384
    s_mul_i32 s91, s65, s86
    buffer_load_dwordx4 v11, s[28:31], s91 offen offset:0  lds
    buffer_load_dwordx4 v12, s[28:31], s91 offen offset:1024  lds
    buffer_load_dwordx4 v13, s[32:35], s91 offen offset:2048  lds
    buffer_load_dwordx4 v14, s[32:35], s91 offen offset:3072  lds
    s_waitcnt vmcnt(12)
    s_barrier
    ds_read_b64_tr_b16 v[128:129], v5 offset:0
    ds_read_b64_tr_b16 v[130:131], v5 offset:512
    ds_read_b128 a[0:3], v36 offset:0
    ds_read_b128 a[4:7], v36 offset:16384
    ds_read_b128 a[8:11], v37 offset:0
    ds_read_b128 a[12:15], v37 offset:16384
    ds_read_b128 a[16:19], v38 offset:0
    ds_read_b128 a[20:23], v38 offset:16384
    ds_read_b128 a[24:27], v39 offset:0
    ds_read_b128 a[28:31], v39 offset:16384
    ds_read_b64_tr_b16 v[132:133], v6 offset:0
    ds_read_b64_tr_b16 v[134:135], v6 offset:512
    ds_read_b64_tr_b16 v[136:137], v5 offset:4096
    ds_read_b64_tr_b16 v[138:139], v5 offset:4608
    ds_read_b64_tr_b16 v[140:141], v6 offset:4096
    ds_read_b64_tr_b16 v[142:143], v6 offset:4608
    s_waitcnt lgkmcnt(4)
    v_mfma_f32_32x32x16_bf16 v[160:175], v[128:131], a[0:3], 0
    s_add_u32 m0, s5, 8192
    ds_read_b64_tr_b16 v[144:145], v5 offset:8192
    ds_read_b64_tr_b16 v[146:147], v5 offset:8704
    s_lshl1_add_u32 s92, s66, s4
    buffer_load_dwordx4 v32, s[24:27], s92 offen offset:0  lds
    s_mov_b32 s48, s22
    v_mfma_f32_32x32x16_bf16 v[176:191], v[128:131], a[4:7], 0
    buffer_load_dwordx4 v33, s[24:27], s92 offen offset:1024  lds
    s_mov_b32 s49, s23
    s_mov_b32 s50, 268435456
    s_mov_b32 s51, 0x20000
    v_mov_b32 v229, 1073741824
    v_mfma_f32_16x16x32_bf16 v[116:119], v[112:115], v[128:131], 0
    v_mfma_f32_32x32x16_bf16 v[192:207], v[132:135], a[0:3], 0
    ds_read_b64_tr_b16 v[148:149], v6 offset:8192
    ds_read_b64_tr_b16 v[150:151], v6 offset:8704
    buffer_load_dwordx4 v34, s[24:27], s92 offen offset:2048  lds
    v_mov_b32 v248, 0
    v_mov_b32 v249, 0
    s_lshl4_add_u32 s95, s79, s80
    v_mfma_f32_32x32x16_bf16 v[208:223], v[132:135], a[4:7], 0
    s_waitcnt lgkmcnt(4)
    buffer_load_dwordx4 v35, s[24:27], s92 offen offset:3072  lds
    s_lshl2_add_u32 s95, s95, s3
    s_lshl_b32 s95, s95, 5
    s_add_u32 s95, s95, 458752
    v_cmp_eq_u32 vcc, 0, v29
    v_lshlrev_b32 v230, 4, v30
    v_mfma_f32_32x32x16_bf16 v[160:175], v[136:139], a[8:11], v[160:175]
    s_add_u32 m0, s101, 32768
    ds_read_b64_tr_b16 v[152:153], v5 offset:12288
    ds_read_b64_tr_b16 v[154:155], v5 offset:12800
    s_mul_i32 s91, s66, s86
    buffer_load_dwordx4 v11, s[28:31], s91 offen offset:0  lds
    s_nop 0
    v_mfma_f32_32x32x16_bf16 v[176:191], v[136:139], a[12:15], v[176:191]
    buffer_load_dwordx4 v12, s[28:31], s91 offen offset:1024  lds
    s_waitcnt vmcnt(15)
    v_cndmask_b32 v230, v229, v230, vcc
    v_readfirstlane_b32 s83, v20
    v_mfma_f32_16x16x32_bf16 v[116:119], v[112:115], v[136:139], v[116:119]
    v_mfma_f32_32x32x16_bf16 v[192:207], v[140:143], a[8:11], v[192:207]
    ds_read_b64_tr_b16 v[156:157], v6 offset:12288
    ds_read_b64_tr_b16 v[158:159], v6 offset:12800
    buffer_load_dwordx4 v13, s[32:35], s91 offen offset:2048  lds
    v_mfma_f32_32x32x16_bf16 v[208:223], v[140:143], a[12:15], v[208:223]
    s_waitcnt lgkmcnt(4)
    buffer_load_dwordx4 v14, s[32:35], s91 offen offset:3072  lds
    v_dot2c_f32_bf16 v248, v240, v64
    v_dot2c_f32_bf16 v249, v240, v240
    v_dot2c_f32_bf16 v248, v241, v64
    v_dot2c_f32_bf16 v249, v241, v241
    v_dot2c_f32_bf16 v248, v242, v64
    v_dot2c_f32_bf16 v249, v242, v242
    v_dot2c_f32_bf16 v248, v243, v64
    v_dot2c_f32_bf16 v249, v243, v243
    v_dot2c_f32_bf16 v248, v244, v64
    v_dot2c_f32_bf16 v249, v244, v244
    v_dot2c_f32_bf16 v248, v245, v64
    v_dot2c_f32_bf16 v249, v245, v245
    v_dot2c_f32_bf16 v248, v246, v64
    v_dot2c_f32_bf16 v249, v246, v246
    v_dot2c_f32_bf16 v248, v247, v64
    v_dot2c_f32_bf16 v249, v247, v247
    v_mfma_f32_32x32x16_bf16 v[160:175], v[144:147], a[16:19], v[160:175]
    s_waitcnt vmcnt(8)
    s_barrier
    ds_read_b64_tr_b16 v[128:129], v5 offset:16384
    ds_read_b64_tr_b16 v[130:131], v5 offset:16896
    v_mfma_f32_32x32x16_bf16 v[176:191], v[144:147], a[20:23], v[176:191]
    s_add_u32 m0, s5, 12288
    ds_read_b128 a[32:35], v36 offset:4096
    ds_read_b128 a[36:39], v36 offset:20480
    s_lshl1_add_u32 s92, s67, s4
    buffer_load_dwordx4 v32, s[24:27], s92 offen offset:0  lds
    v_mfma_f32_16x16x32_bf16 v[116:119], v[112:115], v[144:147], v[116:119]
    v_mfma_f32_32x32x16_bf16 v[192:207], v[148:151], a[16:19], v[192:207]
    ds_read_b64_tr_b16 v[132:133], v6 offset:16384
    ds_read_b64_tr_b16 v[134:135], v6 offset:16896
    ds_read_b128 a[40:43], v37 offset:4096
    ds_read_b128 a[44:47], v37 offset:20480
    buffer_load_dwordx4 v33, s[24:27], s92 offen offset:1024  lds
    v_mfma_f32_32x32x16_bf16 v[208:223], v[148:151], a[20:23], v[208:223]
    s_waitcnt lgkmcnt(8)
    ds_read_b128 a[48:51], v38 offset:4096
    ds_read_b128 a[52:55], v38 offset:20480
    buffer_load_dwordx4 v34, s[24:27], s92 offen offset:2048  lds
    v_mfma_f32_32x32x16_bf16 v[160:175], v[152:155], a[24:27], v[160:175]
    ds_read_b64_tr_b16 v[136:137], v5 offset:20480
    ds_read_b64_tr_b16 v[138:139], v5 offset:20992
    ds_read_b128 a[56:59], v39 offset:4096
    ds_read_b128 a[60:63], v39 offset:20480
    buffer_load_dwordx4 v35, s[24:27], s92 offen offset:3072  lds
    s_mul_i32 s83, s83, 0x9e3779b1
    v_mfma_f32_32x32x16_bf16 v[176:191], v[152:155], a[28:31], v[176:191]
    s_add_u32 m0, s101, 49152
    s_mul_i32 s91, s67, s86
    buffer_load_dwordx4 v11, s[28:31], s91 offen offset:0  lds
    s_add_u32 s83, s83, 0x7f4a7c15
    s_nop 0
    v_mfma_f32_16x16x32_bf16 v[116:119], v[112:115], v[152:155], v[116:119]
    v_mfma_f32_32x32x16_bf16 v[192:207], v[156:159], a[24:27], v[192:207]
    ds_read_b64_tr_b16 v[140:141], v6 offset:20480
    ds_read_b64_tr_b16 v[142:143], v6 offset:20992
    buffer_load_dwordx4 v12, s[28:31], s91 offen offset:1024  lds
    v_add_f32_dpp v248, v248, v248 row_ror:8 row_mask:0xf bank_mask:0xf
    v_add_f32_dpp v249, v249, v249 row_ror:8 row_mask:0xf bank_mask:0xf
    s_nop 0
    v_mfma_f32_32x32x16_bf16 v[208:223], v[156:159], a[28:31], v[208:223]
    s_waitcnt lgkmcnt(10)
    buffer_load_dwordx4 v13, s[32:35], s91 offen offset:2048  lds
    v_add_f32_dpp v248, v248, v248 row_ror:4 row_mask:0xf bank_mask:0xf
    v_add_f32_dpp v249, v249, v249 row_ror:4 row_mask:0xf bank_mask:0xf
    s_nop 0
    v_add_f32_dpp v248, v248, v248 row_ror:2 row_mask:0xf bank_mask:0xf
    v_add_f32_dpp v249, v249, v249 row_ror:2 row_mask:0xf bank_mask:0xf
    v_mfma_f32_32x32x16_bf16 v[160:175], v[128:131], a[32:35], v[160:175]
    ds_read_b64_tr_b16 v[144:145], v5 offset:24576
    ds_read_b64_tr_b16 v[146:147], v5 offset:25088
    buffer_load_dwordx4 v14, s[32:35], s91 offen offset:3072  lds
    s_nop 0
    v_add_f32_dpp v248, v248, v248 row_ror:1 row_mask:0xf bank_mask:0xf
    v_add_f32_dpp v249, v249, v249 row_ror:1 row_mask:0xf bank_mask:0xf
    v_mfma_f32_32x32x16_bf16 v[176:191], v[128:131], a[36:39], v[176:191]
    s_nop 0
    v_mov_b32 v250, v248
    v_mov_b32 v251, v249
    s_nop 0
    v_permlane16_swap_b32 v248, v250
    v_mfma_f32_16x16x32_bf16 v[116:119], v[112:115], v[128:131], v[116:119]
    v_mfma_f32_32x32x16_bf16 v[192:207], v[132:135], a[32:35], v[192:207]
    s_add_u32 m0, s5, 0
    ds_read_b64_tr_b16 v[148:149], v6 offset:24576
    ds_read_b64_tr_b16 v[150:151], v6 offset:25088
    s_lshl1_add_u32 s92, s68, s4
    buffer_load_dwordx4 v32, s[24:27], s92 offen offset:0  lds
    v_permlane16_swap_b32 v249, v251
    v_mfma_f32_32x32x16_bf16 v[208:223], v[132:135], a[36:39], v[208:223]
    s_waitcnt lgkmcnt(4)
    v_add_f32 v248, v248, v250
    v_add_f32 v249, v249, v251
    v_mul_f32 v248, 0xbb000000, v248
    v_mul_f32 v249, 0x3b000000, v249
    v_mov_b32 v250, s83
    v_fma_f32 v249, -v248, v248, v249
    v_mfma_f32_32x32x16_bf16 v[160:175], v[136:139], a[40:43], v[160:175]
    ds_read_b64_tr_b16 v[152:153], v5 offset:28672
    ds_read_b64_tr_b16 v[154:155], v5 offset:29184
    buffer_load_dwordx4 v33, s[24:27], s92 offen offset:1024  lds
    v_mov_b32 v251, s83
    v_max_f32 v249, 0, v249
    v_add_f32 v249, 0x3727c5ac, v249
    v_mfma_f32_32x32x16_bf16 v[176:191], v[136:139], a[44:47], v[176:191]
    buffer_store_dwordx4 v[248:251], v230, s[48:51], s95 offen sc1
    s_lshl_b32 s96, s90, 7
    s_mov_b32 s63, s96
    s_mov_b32 s96, 0
    v_mfma_f32_16x16x32_bf16 v[116:119], v[112:115], v[136:139], v[116:119]
    v_mfma_f32_32x32x16_bf16 v[192:207], v[140:143], a[40:43], v[192:207]
    ds_read_b64_tr_b16 v[156:157], v6 offset:28672
    ds_read_b64_tr_b16 v[158:159], v6 offset:29184
    buffer_load_dwordx4 v34, s[24:27], s92 offen offset:2048  lds
    s_add_u32 s40, s12, s96
    s_addc_u32 s41, s13, 0
    s_sub_u32 s40, s40, 3072
    s_subb_u32 s41, s41, 0
    v_mfma_f32_32x32x16_bf16 v[208:223], v[140:143], a[44:47], v[208:223]
    s_waitcnt lgkmcnt(4)
    s_sub_u32 s42, 1838080, s96
    s_mov_b32 s43, 0x20000
    s_add_u32 s44, s14, s96
    s_addc_u32 s45, s15, 0
    s_sub_u32 s44, s44, 3072
    s_subb_u32 s45, s45, 0
    v_mfma_f32_32x32x16_bf16 v[160:175], v[144:147], a[48:51], v[160:175]
    s_waitcnt vmcnt(12)
    s_barrier
    ds_read_b64_tr_b16 v[128:129], v5 offset:32768
    ds_read_b64_tr_b16 v[130:131], v5 offset:33280
    s_sub_u32 s46, 1838080, s96
    s_mov_b32 s47, 0x20000
    v_mfma_f32_32x32x16_bf16 v[176:191], v[144:147], a[52:55], v[176:191]
    ds_read_b128 a[64:67], v36 offset:8192
    ds_read_b128 a[68:71], v36 offset:24576
    buffer_load_dwordx4 v35, s[24:27], s92 offen offset:3072  lds
    s_and_b32 s97, s88, 0xfffffffe
    s_and_b32 s98, s3, 1
    v_mfma_f32_16x16x32_bf16 v[116:119], v[112:115], v[144:147], v[116:119]
    v_mfma_f32_32x32x16_bf16 v[192:207], v[148:151], a[48:51], v[192:207]
    s_add_u32 m0, s101, 65536
    ds_read_b64_tr_b16 v[132:133], v6 offset:32768
    ds_read_b64_tr_b16 v[134:135], v6 offset:33280
    ds_read_b128 a[72:75], v37 offset:8192
    ds_read_b128 a[76:79], v37 offset:24576
    s_mul_i32 s91, s68, s86
    buffer_load_dwordx4 v11, s[28:31], s91 offen offset:0  lds
    v_mfma_f32_32x32x16_bf16 v[208:223], v[148:151], a[52:55], v[208:223]
    s_waitcnt lgkmcnt(8)
    ds_read_b128 a[80:83], v38 offset:8192
    ds_read_b128 a[84:87], v38 offset:24576
    buffer_load_dwordx4 v12, s[28:31], s91 offen offset:1024  lds
    s_mul_i32 s88, s97, 147456
    s_add_u32 s88, s88, 8388608
    s_lshl1_add_u32 s96, s90, s98
    v_mfma_f32_32x32x16_bf16 v[160:175], v[152:155], a[56:59], v[160:175]
    ds_read_b64_tr_b16 v[136:137], v5 offset:36864
    ds_read_b64_tr_b16 v[138:139], v5 offset:37376
    ds_read_b128 a[88:91], v39 offset:8192
    ds_read_b128 a[92:95], v39 offset:24576
    buffer_load_dwordx4 v13, s[32:35], s91 offen offset:2048  lds
    s_lshl_b32 s96, s96, 11
    v_mfma_f32_32x32x16_bf16 v[176:191], v[152:155], a[60:63], v[176:191]
    buffer_load_dwordx4 v14, s[32:35], s91 offen offset:3072  lds
    s_add_u32 s88, s88, s96
    s_lshl1_add_u32 s96, s89, s98
    s_lshl4_add_u32 s87, s97, s96
    s_lshl_b32 s87, s87, 12
    v_mfma_f32_16x16x32_bf16 v[116:119], v[112:115], v[152:155], v[116:119]
    v_mfma_f32_32x32x16_bf16 v[192:207], v[156:159], a[56:59], v[192:207]
    ds_read_b64_tr_b16 v[140:141], v6 offset:36864
    ds_read_b64_tr_b16 v[142:143], v6 offset:37376
    s_add_u32 s87, s87, 4194304
    s_sub_u32 s96, s90, s76
    s_lshl_b32 s96, s96, 12
    s_sub_u32 s96, s88, s96
    v_mfma_f32_32x32x16_bf16 v[208:223], v[156:159], a[60:63], v[208:223]
    s_add_u32 m0, s5, 4096
    s_waitcnt lgkmcnt(10)
    s_lshl1_add_u32 s92, s69, s4
    buffer_load_dwordx4 v32, s[24:27], s92 offen offset:0  lds
    s_mov_b32 s95, s77
    s_sub_u32 s98, s99, 1
    v_mfma_f32_32x32x16_bf16 v[160:175], v[128:131], a[64:67], v[160:175]
    ds_read_b64_tr_b16 v[144:145], v5 offset:40960
    ds_read_b64_tr_b16 v[146:147], v5 offset:41472
    s_cmp_eq_u32 s99, 0
    s_cselect_b32 s87, s87, s96
    s_cselect_b32 s95, s89, s95
    s_cselect_b32 s98, 0, s98
    s_lshl_b32 s96, s98, 10
    v_mfma_f32_32x32x16_bf16 v[176:191], v[128:131], a[68:71], v[176:191]
    buffer_load_dwordx4 v33, s[24:27], s92 offen offset:1024  lds
    s_lshl_b32 s89, s95, 7
    s_add_u32 s96, s96, s89
    s_mov_b32 s75, s96
    s_mov_b32 s96, 0
    v_mfma_f32_16x16x32_bf16 v[116:119], v[112:115], v[128:131], v[116:119]
    v_mfma_f32_32x32x16_bf16 v[192:207], v[132:135], a[64:67], v[192:207]
    ds_read_b64_tr_b16 v[148:149], v6 offset:40960
    ds_read_b64_tr_b16 v[150:151], v6 offset:41472
    s_add_u32 s36, s6, s96
    s_addc_u32 s37, s7, 0
    s_sub_u32 s38, 1572864, s96
    s_mov_b32 s39, 0x20000
    v_mfma_f32_32x32x16_bf16 v[208:223], v[132:135], a[68:71], v[208:223]
    s_waitcnt lgkmcnt(4)
    buffer_load_dwordx4 v34, s[24:27], s92 offen offset:2048  lds
    s_mov_b64 s[20:21], s[8:9]
    v_mul_u32_u24 v44, 3584, v28
    v_add_u32 v44, 3072, v44
    v_add_u32 v44, v44, v27
    v_add_u32 v45, 27648, v44
    v_mfma_f32_32x32x16_bf16 v[160:175], v[136:139], a[72:75], v[160:175]
    ds_read_b64_tr_b16 v[152:153], v5 offset:45056
    ds_read_b64_tr_b16 v[154:155], v5 offset:45568
    v_xor_b32 v46, 64, v44
    v_xor_b32 v47, 64, v45
    v_subrev_u32 v46, 2048, v46
    v_subrev_u32 v47, 2048, v47
    v_mfma_f32_32x32x16_bf16 v[176:191], v[136:139], a[76:79], v[176:191]
    buffer_load_dwordx4 v35, s[24:27], s92 offen offset:3072  lds
    v_bfe_u32 v228, v24, 4, 1
    v_lshlrev_b32 v228, 2, v228
    v_xor_b32 v228, v228, v26
    v_lshlrev_b32 v228, 4, v228
    v_mfma_f32_16x16x32_bf16 v[116:119], v[112:115], v[136:139], v[116:119]
    v_mfma_f32_32x32x16_bf16 v[192:207], v[140:143], a[72:75], v[192:207]
    ds_read_b64_tr_b16 v[156:157], v6 offset:45056
    ds_read_b64_tr_b16 v[158:159], v6 offset:45568
    v_mul_u32_u24 v40, 3072, v25
    v_add_u32 v40, v40, v228
    v_add_u32 v41, 23552, v40
    v_add_u32 v42, 47104, v40
    v_mfma_f32_32x32x16_bf16 v[208:223], v[140:143], a[76:79], v[208:223]
    s_add_u32 m0, s101, 0
    s_waitcnt lgkmcnt(4)
    s_mul_i32 s91, s69, s86
    buffer_load_dwordx4 v11, s[28:31], s91 offen offset:0  lds
    v_add_u32 v43, 70656, v40
    v_add_u32 v44, s63, v44
    v_add_u32 v40, s75, v40
    v_mfma_f32_32x32x16_bf16 v[160:175], v[144:147], a[80:83], v[160:175]
    s_waitcnt vmcnt(14)
    s_barrier
    ds_read_b64_tr_b16 v[128:129], v5 offset:49152
    ds_read_b64_tr_b16 v[130:131], v5 offset:49664
    v_add_u32 v45, s63, v45
    v_add_u32 v41, s75, v41
    v_mfma_f32_32x32x16_bf16 v[176:191], v[144:147], a[84:87], v[176:191]
    ds_read_b128 a[96:99], v36 offset:12288
    ds_read_b128 a[100:103], v36 offset:28672
    buffer_load_dwordx4 v12, s[28:31], s91 offen offset:1024  lds
    v_add_u32 v46, s63, v46
    v_add_u32 v42, s75, v42
    v_mfma_f32_16x16x32_bf16 v[116:119], v[112:115], v[144:147], v[116:119]
    v_mfma_f32_32x32x16_bf16 v[192:207], v[148:151], a[80:83], v[192:207]
    ds_read_b64_tr_b16 v[132:133], v6 offset:49152
    ds_read_b64_tr_b16 v[134:135], v6 offset:49664
    ds_read_b128 a[104:107], v37 offset:12288
    ds_read_b128 a[108:111], v37 offset:28672
    buffer_load_dwordx4 v13, s[32:35], s91 offen offset:2048  lds
    v_add_u32 v47, s63, v47
    v_mfma_f32_32x32x16_bf16 v[208:223], v[148:151], a[84:87], v[208:223]
    s_waitcnt lgkmcnt(8)
    ds_read_b128 a[112:115], v38 offset:12288
    ds_read_b128 a[116:119], v38 offset:28672
    buffer_load_dwordx4 v14, s[32:35], s91 offen offset:3072  lds
    v_add_u32 v43, s75, v43
    s_and_b32 s96, s3, 1
    s_lshl_b32 s96, s96, 5
    v_mfma_f32_32x32x16_bf16 v[160:175], v[152:155], a[88:91], v[160:175]
    ds_read_b64_tr_b16 v[136:137], v5 offset:53248
    ds_read_b64_tr_b16 v[138:139], v5 offset:53760
    ds_read_b128 a[120:123], v39 offset:12288
    ds_read_b128 a[124:127], v39 offset:28672
    v_mfma_f32_32x32x16_bf16 v[176:191], v[152:155], a[92:95], v[176:191]
    s_add_u32 m0, s5, 8192
    s_lshl1_add_u32 s92, s70, s4
    buffer_load_dwordx4 v32, s[24:27], s92 offen offset:0  lds
    s_cmp_lt_u32 s3, 2
    s_cselect_b32 s72, s64, s65
    s_cselect_b32 s73, s66, s67
    s_cselect_b32 s74, s68, s69
    s_cselect_b32 s75, s70, s71
    v_mfma_f32_16x16x32_bf16 v[116:119], v[112:115], v[152:155], v[116:119]
    v_mfma_f32_32x32x16_bf16 v[192:207], v[156:159], a[88:91], v[192:207]
    ds_read_b64_tr_b16 v[140:141], v6 offset:53248
    ds_read_b64_tr_b16 v[142:143], v6 offset:53760
    s_add_u32 s72, s72, s96
    s_mul_i32 s72, s72, 3072
    s_add_u32 s73, s73, s96
    v_mfma_f32_32x32x16_bf16 v[208:223], v[156:159], a[92:95], v[208:223]
    s_waitcnt lgkmcnt(10)
    buffer_load_dwordx4 v33, s[24:27], s92 offen offset:1024  lds
    s_mul_i32 s73, s73, 3072
    s_add_u32 s74, s74, s96
    s_mul_i32 s74, s74, 3072
    s_add_u32 s75, s75, s96
    s_mul_i32 s75, s75, 3072
    v_mfma_f32_32x32x16_bf16 v[160:175], v[128:131], a[96:99], v[160:175]
    ds_read_b64_tr_b16 v[144:145], v5 offset:57344
    ds_read_b64_tr_b16 v[146:147], v5 offset:57856
    s_and_b32 s96, s3, 1
    s_lshl1_add_u32 s95, s95, s96
    s_lshl4_add_u32 s97, s97, s95
    s_lshl_b32 s89, s97, 11
    v_mfma_f32_32x32x16_bf16 v[176:191], v[128:131], a[100:103], v[176:191]
    buffer_load_dwordx4 v34, s[24:27], s92 offen offset:2048  lds
    s_add_u32 s89, s89, 1048576
    s_add_u32 s90, s89, 32768
    s_lshl_b32 s97, s97, 12
    s_add_u32 s97, s97, 4192256
    v_mfma_f32_16x16x32_bf16 v[116:119], v[112:115], v[128:131], v[116:119]
    v_mfma_f32_32x32x16_bf16 v[192:207], v[132:135], a[96:99], v[192:207]
    ds_read_b64_tr_b16 v[148:149], v6 offset:57344
    ds_read_b64_tr_b16 v[150:151], v6 offset:57856
    s_lshl_b32 s96, s98, 11
    s_add_u32 s97, s97, s96
    s_add_u32 s96, s97, 65536
    v_mfma_f32_32x32x16_bf16 v[208:223], v[132:135], a[100:103], v[208:223]
    s_waitcnt lgkmcnt(4)
    buffer_load_dwordx4 v35, s[24:27], s92 offen offset:3072  lds
    s_cmp_eq_u32 s98, 0
    s_cselect_b32 s89, s89, s97
    s_cselect_b32 s90, s90, s96
    s_mov_b32 s84, 0xbf317218
    s_cselect_b32 s84, 0xbe800000, s84
    s_lshl_b32 s96, s82, 7
    v_mfma_f32_32x32x16_bf16 v[160:175], v[136:139], a[104:107], v[160:175]
    ds_read_b64_tr_b16 v[152:153], v5 offset:61440
    ds_read_b64_tr_b16 v[154:155], v5 offset:61952
    s_mov_b32 s63, s96
    s_mov_b32 s96, 0
    s_add_u32 s52, s16, s96
    s_addc_u32 s53, s17, 0
    v_mfma_f32_32x32x16_bf16 v[176:191], v[136:139], a[108:111], v[176:191]
    s_add_u32 m0, s101, 16384
    s_mul_i32 s91, s70, s86
    buffer_load_dwordx4 v11, s[28:31], s91 offen offset:0  lds
    s_sub_u32 s54, 1835008, s96
    s_mov_b32 s55, 0x20000
    v_mfma_f32_16x16x32_bf16 v[116:119], v[112:115], v[136:139], v[116:119]
    v_mfma_f32_32x32x16_bf16 v[192:207], v[140:143], a[104:107], v[192:207]
    ds_read_b64_tr_b16 v[156:157], v6 offset:61440
    ds_read_b64_tr_b16 v[158:159], v6 offset:61952
    s_add_u32 s56, s20, s96
    s_addc_u32 s57, s21, 0
    s_sub_u32 s58, 524288, s96
    s_mov_b32 s59, 0x20000
    v_mfma_f32_32x32x16_bf16 v[208:223], v[140:143], a[108:111], v[208:223]
    s_waitcnt lgkmcnt(4)
    buffer_load_dwordx4 v12, s[28:31], s91 offen offset:1024  lds
    s_and_b32 s97, s81, 3
    s_add_u32 s96, s82, s97
    s_lshl1_add_u32 s82, s97, s82
    v_add_u32 v5, 65536, v5
    v_add_u32 v6, 65536, v6
    v_mfma_f32_32x32x16_bf16 v[160:175], v[144:147], a[112:115], v[160:175]
    s_waitcnt vmcnt(14)
    s_barrier
    ds_read_b64_tr_b16 v[128:129], v5 offset:0
    ds_read_b64_tr_b16 v[130:131], v5 offset:512
    s_mul_i32 s97, s96, 43
    s_lshr_b32 s97, s97, 7
    v_mfma_f32_32x32x16_bf16 v[176:191], v[144:147], a[116:119], v[176:191]
    ds_read_b128 a[128:131], v36 offset:0
    ds_read_b128 a[132:135], v36 offset:16384
    buffer_load_dwordx4 v13, s[32:35], s91 offen offset:2048  lds
    s_mul_i32 s97, s97, 3
    s_sub_u32 s96, s96, s97
    v_mfma_f32_16x16x32_bf16 v[116:119], v[112:115], v[144:147], v[116:119]
    v_mfma_f32_32x32x16_bf16 v[192:207], v[148:151], a[112:115], v[192:207]
    ds_read_b64_tr_b16 v[132:133], v6 offset:0
    ds_read_b64_tr_b16 v[134:135], v6 offset:512
    ds_read_b128 a[136:139], v37 offset:0
    ds_read_b128 a[140:143], v37 offset:16384
    buffer_load_dwordx4 v14, s[32:35], s91 offen offset:3072  lds
    s_add_u32 s60, s96, 0
    v_mfma_f32_32x32x16_bf16 v[208:223], v[148:151], a[116:119], v[208:223]
    s_waitcnt lgkmcnt(8)
    ds_read_b128 a[144:147], v38 offset:0
    ds_read_b128 a[148:151], v38 offset:16384
    s_sub_u32 s97, s60, 3
    s_cmp_ge_u32 s60, 3
    s_cselect_b32 s60, s97, s60
    s_lshl_b32 s60, s60, 13
    v_mfma_f32_32x32x16_bf16 v[160:175], v[152:155], a[120:123], v[160:175]
    s_add_u32 m0, s5, 12288
    ds_read_b64_tr_b16 v[136:137], v5 offset:4096
    ds_read_b64_tr_b16 v[138:139], v5 offset:4608
    ds_read_b128 a[152:155], v39 offset:0
    ds_read_b128 a[156:159], v39 offset:16384
    s_lshl1_add_u32 s92, s71, s4
    buffer_load_dwordx4 v32, s[24:27], s92 offen offset:0  lds
    v_mfma_f32_32x32x16_bf16 v[176:191], v[152:155], a[124:127], v[176:191]
    s_add_u32 s60, s60, 4096
    s_add_u32 s61, s96, 1
    s_sub_u32 s97, s61, 3
    s_cmp_ge_u32 s61, 3
    s_cselect_b32 s61, s97, s61
    v_mfma_f32_16x16x32_bf16 v[116:119], v[112:115], v[152:155], v[116:119]
    v_mfma_f32_32x32x16_bf16 v[192:207], v[156:159], a[120:123], v[192:207]
    ds_read_b64_tr_b16 v[140:141], v6 offset:4096
    ds_read_b64_tr_b16 v[142:143], v6 offset:4608
    buffer_load_dwordx4 v33, s[24:27], s92 offen offset:1024  lds
    s_lshl_b32 s61, s61, 13
    s_add_u32 s61, s61, 4096
    s_add_u32 s62, s96, 2
    v_mfma_f32_32x32x16_bf16 v[208:223], v[156:159], a[124:127], v[208:223]
    s_waitcnt lgkmcnt(10)
    s_sub_u32 s97, s62, 3
    s_cmp_ge_u32 s62, 3
    s_cselect_b32 s62, s97, s62
    s_lshl_b32 s62, s62, 13
    s_add_u32 s62, s62, 4096
    s_mov_b32 s85, 0xffff0000
    v_mfma_f32_32x32x16_bf16 v[160:175], v[128:131], a[128:131], v[160:175]
    ds_read_b64_tr_b16 v[144:145], v5 offset:8192
    ds_read_b64_tr_b16 v[146:147], v5 offset:8704
    buffer_load_dwordx4 v34, s[24:27], s92 offen offset:2048  lds
    s_mul_i32 s100, s81, 294912
    s_mul_i32 s97, s3, 28672
    s_add_u32 s100, s100, s97
    v_mfma_f32_32x32x16_bf16 v[176:191], v[128:131], a[132:135], v[176:191]
    s_add_u32 s100, s100, 8388608
    s_mul_i32 s76, s3, 458752
    s_and_b32 s96, s81, 0
    s_lshl1_add_u32 s78, s3, s96
    s_lshl_b32 s78, s78, 16
    v_mfma_f32_16x16x32_bf16 v[116:119], v[112:115], v[128:131], v[116:119]
    v_mfma_f32_32x32x16_bf16 v[192:207], v[132:135], a[128:131], v[192:207]
    ds_read_b64_tr_b16 v[148:149], v6 offset:8192
    ds_read_b64_tr_b16 v[150:151], v6 offset:8704
    buffer_load_dwordx4 v35, s[24:27], s92 offen offset:3072  lds
    s_lshl_b32 s77, s3, 13
    s_add_u32 s77, s77, 131072
    s_lshr_b32 s97, s3, 1
    v_mfma_f32_32x32x16_bf16 v[208:223], v[132:135], a[132:135], v[208:223]
    s_waitcnt lgkmcnt(4)
    s_lshl_b32 s97, s97, 10
    s_add_u32 s87, s87, s97
    s_add_u32 s88, s88, s97
    v_lshlrev_b32 v228, 1, v227
    v_xor_b32 v228, v228, v224
    v_lshlrev_b32 v228, 5, v228
    v_mfma_f32_32x32x16_bf16 v[160:175], v[136:139], a[136:139], v[160:175]
    s_add_u32 m0, s101, 32768
    ds_read_b64_tr_b16 v[152:153], v5 offset:12288
    ds_read_b64_tr_b16 v[154:155], v5 offset:12800
    s_mul_i32 s91, s71, s86
    buffer_load_dwordx4 v11, s[28:31], s91 offen offset:0  lds
    v_lshl_add_u32 v228, v226, 3, v228
    v_mfma_f32_32x32x16_bf16 v[176:191], v[136:139], a[140:143], v[176:191]
    v_lshl_add_u32 v228, v225, 7, v228
    v_lshl_add_u32 v228, v30, 9, v228
    s_and_b32 s96, s3, 1
    s_lshl_b32 s96, s96, 6
    v_xor_b32 v228, s96, v228
    v_mfma_f32_16x16x32_bf16 v[116:119], v[112:115], v[136:139], v[116:119]
    v_mfma_f32_32x32x16_bf16 v[192:207], v[140:143], a[136:139], v[192:207]
    ds_read_b64_tr_b16 v[156:157], v6 offset:12288
    ds_read_b64_tr_b16 v[158:159], v6 offset:12800
    buffer_load_dwordx4 v12, s[28:31], s91 offen offset:1024  lds
    v_add_u32 v15, s77, v228
    v_lshl_add_u32 v9, v30, 9, v228
    v_xor_b32 v16, 64, v15
    v_mfma_f32_32x32x16_bf16 v[208:223], v[140:143], a[140:143], v[208:223]
    s_waitcnt lgkmcnt(4)
    v_lshlrev_b32 v228, 2, v224
    v_xor_b32 v228, v228, v26
    v_lshlrev_b32 v228, 4, v228
    v_lshl_add_u32 v17, v25, 10, v228
    v_subrev_u32 v5, 65536, v5
    v_subrev_u32 v6, 65536, v6
    v_mfma_f32_32x32x16_bf16 v[160:175], v[144:147], a[144:147], v[160:175]
    s_waitcnt vmcnt(14)
    s_barrier
    ds_read_b64_tr_b16 v[128:129], v5 offset:0
    ds_read_b64_tr_b16 v[130:131], v5 offset:512
    v_add_u32 v17, s63, v17
    v_add_u32 v18, 7168, v17
    v_mfma_f32_32x32x16_bf16 v[176:191], v[144:147], a[148:151], v[176:191]
    ds_read_b128 a[160:163], v36 offset:4096
    ds_read_b128 a[164:167], v36 offset:20480
    buffer_load_dwordx4 v13, s[32:35], s91 offen offset:2048  lds
    s_lshl_b32 s97, s3, 7
    s_add_u32 s97, s97, 65536
    v_mfma_f32_16x16x32_bf16 v[116:119], v[112:115], v[144:147], v[116:119]
    v_mfma_f32_32x32x16_bf16 v[192:207], v[148:151], a[144:147], v[192:207]
    ds_read_b64_tr_b16 v[132:133], v6 offset:0
    ds_read_b64_tr_b16 v[134:135], v6 offset:512
    ds_read_b128 a[168:171], v37 offset:4096
    ds_read_b128 a[172:175], v37 offset:20480
    buffer_load_dwordx4 v14, s[32:35], s91 offen offset:3072  lds
    v_lshl_add_u32 v124, v29, 2, s97
    v_mfma_f32_32x32x16_bf16 v[208:223], v[148:151], a[148:151], v[208:223]
    s_waitcnt lgkmcnt(8)
    ds_read_b128 a[176:179], v38 offset:4096
    ds_read_b128 a[180:183], v38 offset:20480
    v_xor_b32 v125, 256, v124
    v_mov_b32 v68, -1
    v_mov_b32 v69, -1
    v_mov_b32 v70, -1
    v_mfma_f32_32x32x16_bf16 v[160:175], v[152:155], a[152:155], v[160:175]
    s_add_u32 m0, s101, 49152
    ds_read_b64_tr_b16 v[136:137], v5 offset:4096
    ds_read_b64_tr_b16 v[138:139], v5 offset:4608
    ds_read_b128 a[184:187], v39 offset:4096
    ds_read_b128 a[188:191], v39 offset:20480
    buffer_load_dwordx4 v40, s[36:39], s72 offen offset:0  lds
    v_mfma_f32_32x32x16_bf16 v[176:191], v[152:155], a[156:159], v[176:191]
    v_mov_b32 v71, -1
    s_lshl2_add_u32 s63, s79, s3
    s_mul_i32 s63, s63, 147456
    s_lshl_b32 s96, s80, 11
    s_add_u32 s63, s63, s96
    v_mfma_f32_16x16x32_bf16 v[116:119], v[112:115], v[152:155], v[116:119]
    v_mfma_f32_32x32x16_bf16 v[192:207], v[156:159], a[152:155], v[192:207]
    ds_read_b64_tr_b16 v[140:141], v6 offset:4096
    ds_read_b64_tr_b16 v[142:143], v6 offset:4608
    buffer_load_dwordx4 v41, s[36:39], s72 offen offset:1024  lds
    s_add_u32 s63, s63, 8503296
    v_mov_b32 v97, 0
    v_mov_b32 v98, 0
    v_mfma_f32_32x32x16_bf16 v[208:223], v[156:159], a[156:159], v[208:223]
    s_waitcnt lgkmcnt(10)
    v_mov_b32 v99, 0
    v_mov_b32 v101, 0
    v_mov_b32 v102, 0
    v_mov_b32 v103, 0
    v_mov_b32 v105, 0
    v_mov_b32 v106, 0
    v_mfma_f32_32x32x16_bf16 v[160:175], v[128:131], a[160:163], v[160:175]
    ds_read_b64_tr_b16 v[144:145], v5 offset:8192
    ds_read_b64_tr_b16 v[146:147], v5 offset:8704
    buffer_load_dwordx4 v42, s[36:39], s72 offen offset:2048  lds
    v_mov_b32 v107, 0
    v_mov_b32 v109, 0
    v_mov_b32 v110, 0
    v_mfma_f32_32x32x16_bf16 v[176:191], v[128:131], a[164:167], v[176:191]
    v_mov_b32 v111, 0
    s_lshl4_add_u32 s97, s79, s80
    s_lshl2_add_u32 s97, s97, s3
    s_lshl_b32 s97, s97, 7
    v_mov_b32 v228, s97
    v_mfma_f32_16x16x32_bf16 v[116:119], v[112:115], v[128:131], v[116:119]
    v_mfma_f32_32x32x16_bf16 v[192:207], v[132:135], a[160:163], v[192:207]
    ds_read_b64_tr_b16 v[148:149], v6 offset:8192
    ds_read_b64_tr_b16 v[150:151], v6 offset:8704
    buffer_load_dwordx4 v43, s[36:39], s72 offen offset:3072  lds
    v_cmp_eq_u32 vcc, 0, v24
    s_lshr_b32 s95, s80, 1
    s_and_b32 s98, s95, 3
    v_mfma_f32_32x32x16_bf16 v[208:223], v[132:135], a[164:167], v[208:223]
    s_waitcnt lgkmcnt(4)
    v_cndmask_b32 v19, v229, v228, vcc
    s_lshl_b32 s98, s98, 2
    v_and_b32 v55, 511, v1
    s_lshr_b32 s10, s4, 16
    s_lshl_b32 s10, s10, 10
    s_add_u32 s10, s10, 458752
    v_mfma_f32_32x32x16_bf16 v[160:175], v[136:139], a[168:171], v[160:175]
    ds_read_b64_tr_b16 v[152:153], v5 offset:12288
    ds_read_b64_tr_b16 v[154:155], v5 offset:12800
    buffer_load_dwordx4 v[56:59], v55, s[48:51], s10 offen offset:0 sc1
    s_cmp_eq_u32 s95, 3
    s_cselect_b32 s98, 0, s98
    s_cselect_b32 s96, 1, 0
    v_mfma_f32_32x32x16_bf16 v[176:191], v[136:139], a[172:175], v[176:191]
    buffer_load_dwordx4 v[60:63], v55, s[48:51], s10 offen offset:512 sc1
    s_cmp_eq_u32 s95, 4
    s_cselect_b32 s98, 12, s98
    s_cmp_gt_u32 s95, 4
    s_cselect_b32 s95, 1, s96
    v_mfma_f32_16x16x32_bf16 v[116:119], v[112:115], v[136:139], v[116:119]
    v_mfma_f32_32x32x16_bf16 v[192:207], v[140:143], a[168:171], v[192:207]
    ds_read_b64_tr_b16 v[156:157], v6 offset:12288
    ds_read_b64_tr_b16 v[158:159], v6 offset:12800
    s_and_b32 s11, s2, 1
    s_lshl3_add_u32 s11, s11, s64
    s_mul_i32 s11, s11, 3584
    buffer_load_dword v54, v44, s[40:43], s11 offen offset:0
    v_mfma_f32_32x32x16_bf16 v[208:223], v[140:143], a[172:175], v[208:223]
    s_waitcnt lgkmcnt(4)
    s_mul_i32 s93, s3, 3
    s_lshl2_add_u32 s93, s79, s93
    s_sub_u32 s93, s93, 8
    v_cmp_gt_u32 vcc, 3, v24
    v_mov_b32 v230, 3
    v_subrev_u32 v231, 3, v24
    v_mfma_f32_32x32x16_bf16 v[160:175], v[144:147], a[176:179], v[160:175]
    s_waitcnt vmcnt(15)
    s_barrier
    ds_read_b64_tr_b16 v[128:129], v5 offset:16384
    ds_read_b64_tr_b16 v[130:131], v5 offset:16896
    v_cndmask_b32 v230, v230, 2, vcc
    v_cndmask_b32 v231, v231, v24, vcc
    v_mfma_f32_32x32x16_bf16 v[176:191], v[144:147], a[180:183], v[176:191]
    ds_read_b128 a[192:195], v36 offset:8192
    ds_read_b128 a[196:199], v36 offset:24576
    s_and_b32 s11, s2, 1
    s_lshl3_add_u32 s11, s11, s64
    s_mul_i32 s11, s11, 3584
    buffer_load_dword v54, v46, s[44:47], s11 offen offset:2048
    v_add_u32 v231, s93, v231
    v_mfma_f32_16x16x32_bf16 v[116:119], v[112:115], v[144:147], v[116:119]
    v_mfma_f32_32x32x16_bf16 v[192:207], v[148:151], a[176:179], v[192:207]
    s_add_u32 m0, s101, 65536
    ds_read_b64_tr_b16 v[132:133], v6 offset:16384
    ds_read_b64_tr_b16 v[134:135], v6 offset:16896
    ds_read_b128 a[200:203], v37 offset:8192
    ds_read_b128 a[204:207], v37 offset:24576
    buffer_load_dwordx4 v40, s[36:39], s73 offen offset:0  lds
    v_mfma_f32_32x32x16_bf16 v[208:223], v[148:151], a[180:183], v[208:223]
    s_waitcnt lgkmcnt(8)
    ds_read_b128 a[208:211], v38 offset:8192
    ds_read_b128 a[212:215], v38 offset:24576
    v_cmp_eq_u32 vcc, 6, v24
    v_lshrrev_b32 v23, 4, v0
    s_mul_i32 s11, s2, 7168
    v_min_u32 v23, 13, v23
    s_add_u32 s11, s11, 0
    v_lshl_add_u32 v23, v23, 7, s11
    v_mfma_f32_32x32x16_bf16 v[160:175], v[152:155], a[184:187], v[160:175]
    ds_read_b64_tr_b16 v[136:137], v5 offset:20480
    ds_read_b64_tr_b16 v[138:139], v5 offset:20992
    ds_read_b128 a[216:219], v39 offset:8192
    ds_read_b128 a[220:223], v39 offset:24576
    global_load_dword v54, v23, s[16:17]
    s_lshl2_add_u32 s96, s79, s3
    v_mfma_f32_32x32x16_bf16 v[176:191], v[152:155], a[188:191], v[176:191]
    buffer_load_dwordx4 v41, s[36:39], s73 offen offset:1024  lds
    v_mov_b32 v232, s96
    v_cndmask_b32 v230, v230, 1, vcc
    v_cndmask_b32 v231, v231, v232, vcc
    v_mul_u32_u24 v230, s95, v230
    v_mfma_f32_16x16x32_bf16 v[116:119], v[112:115], v[152:155], v[116:119]
    v_mfma_f32_32x32x16_bf16 v[192:207], v[156:159], a[184:187], v[192:207]
    ds_read_b64_tr_b16 v[140:141], v6 offset:20480
    ds_read_b64_tr_b16 v[142:143], v6 offset:20992
    v_add_u32 v230, s98, v230
    v_subrev_u32 v232, 7, v24
    v_lshrrev_b32 v233, 1, v232
    s_lshl_b32 s96, s3, 2
    v_mfma_f32_32x32x16_bf16 v[208:223], v[156:159], a[188:191], v[208:223]
    s_waitcnt lgkmcnt(10)
    buffer_load_dwordx4 v42, s[36:39], s73 offen offset:2048  lds
    v_add_u32 v233, s96, v233
    v_lshrrev_b32 v23, 4, v0
    s_mul_i32 s11, s2, 7168
    v_min_u32 v23, 13, v23
    s_add_u32 s11, s11, 1792
    v_lshl_add_u32 v23, v23, 7, s11
    v_mfma_f32_32x32x16_bf16 v[160:175], v[128:131], a[192:195], v[160:175]
    ds_read_b64_tr_b16 v[144:145], v5 offset:24576
    ds_read_b64_tr_b16 v[146:147], v5 offset:25088
    global_load_dword v54, v23, s[16:17]
    v_and_b32 v232, 1, v232
    s_lshl_b32 s96, s81, 1
    v_cmp_le_u32 vcc, 7, v24
    v_mfma_f32_32x32x16_bf16 v[176:191], v[128:131], a[196:199], v[176:191]
    buffer_load_dwordx4 v43, s[36:39], s73 offen offset:3072  lds
    v_add_u32 v232, s96, v232
    s_nop 0
    v_cndmask_b32 v230, v230, v233, vcc
    v_cndmask_b32 v231, v231, v232, vcc
    v_mfma_f32_16x16x32_bf16 v[116:119], v[112:115], v[128:131], v[116:119]
    v_mfma_f32_32x32x16_bf16 v[192:207], v[132:135], a[192:195], v[192:207]
    ds_read_b64_tr_b16 v[148:149], v6 offset:24576
    ds_read_b64_tr_b16 v[150:151], v6 offset:25088
    v_cmp_le_i32 vcc, 0, v231
    v_cmp_gt_u32 s[0:1], 15, v24
    v_lshrrev_b32 v232, 2, v231
    v_lshl_add_u32 v232, v232, 4, v230
    v_mfma_f32_32x32x16_bf16 v[208:223], v[132:135], a[196:199], v[208:223]
    s_waitcnt lgkmcnt(4)
    v_and_b32 v231, 3, v231
    v_lshrrev_b32 v23, 4, v0
    s_mul_i32 s11, s2, 7168
    v_min_u32 v23, 13, v23
    s_add_u32 s11, s11, 3584
    v_lshl_add_u32 v23, v23, 7, s11
    v_mfma_f32_32x32x16_bf16 v[160:175], v[136:139], a[200:203], v[160:175]
    ds_read_b64_tr_b16 v[152:153], v5 offset:28672
    ds_read_b64_tr_b16 v[154:155], v5 offset:29184
    global_load_dword v54, v23, s[16:17]
    s_and_b64 s[0:1], s[0:1], vcc
    v_cmp_gt_u32 vcc, 7, v24
    s_and_b32 s96, s80, 1
    v_mfma_f32_32x32x16_bf16 v[176:191], v[136:139], a[204:207], v[176:191]
    v_and_b32 v233, 2, v231
    v_or_b32 v233, s96, v233
    v_cndmask_b32 v231, v231, v233, vcc
    v_lshl_add_u32 v232, v232, 2, v231
    v_lshlrev_b32 v232, 7, v232
    v_mfma_f32_16x16x32_bf16 v[116:119], v[112:115], v[136:139], v[116:119]
    v_mfma_f32_32x32x16_bf16 v[192:207], v[140:143], a[200:203], v[192:207]
    ds_read_b64_tr_b16 v[156:157], v6 offset:28672
    ds_read_b64_tr_b16 v[158:159], v6 offset:29184
    s_mul_i32 s94, s3, 12480
    v_cndmask_b32 v22, v229, v232, s[0:1]
    s_and_b32 s0, s0, 0x7f
    s_add_u32 s96, s101, 147456
    v_mfma_f32_32x32x16_bf16 v[208:223], v[140:143], a[204:207], v[208:223]
    s_waitcnt lgkmcnt(4)
    s_sub_u32 s96, s96, s77
    v_add_u32 v126, s96, v15
    v_add_u32 v127, s96, v16
    s_sub_u32 s96, s5, s77
    v_add_u32 v2, s96, v15
    v_add_u32 v28, s96, v16
    v_mfma_f32_32x32x16_bf16 v[160:175], v[144:147], a[208:211], v[160:175]
    s_waitcnt vmcnt(15)
    s_barrier
    ds_read_b64_tr_b16 v[128:129], v5 offset:32768
    ds_read_b64_tr_b16 v[130:131], v5 offset:33280
    v_lshrrev_b32 v23, 4, v0
    s_mul_i32 s11, s2, 7168
    v_min_u32 v23, 13, v23
    s_add_u32 s11, s11, 5376
    v_lshl_add_u32 v23, v23, 7, s11
    v_mfma_f32_32x32x16_bf16 v[176:191], v[144:147], a[212:215], v[176:191]
    ds_read_b128 a[224:227], v36 offset:12288
    ds_read_b128 a[228:231], v36 offset:28672
    global_load_dword v54, v23, s[16:17]
    v_mfma_f32_16x16x32_bf16 v[116:119], v[112:115], v[144:147], v[116:119]
    v_mfma_f32_32x32x16_bf16 v[192:207], v[148:151], a[208:211], v[192:207]
    s_add_u32 m0, s101, 0
    ds_read_b64_tr_b16 v[132:133], v6 offset:32768
    ds_read_b64_tr_b16 v[134:135], v6 offset:33280
    ds_read_b128 a[232:235], v37 offset:12288
    ds_read_b128 a[236:239], v37 offset:28672
    buffer_load_dwordx4 v40, s[36:39], s74 offen offset:0  lds
    v_mfma_f32_32x32x16_bf16 v[208:223], v[148:151], a[212:215], v[208:223]
    s_waitcnt lgkmcnt(8)
    ds_read_b128 a[240:243], v38 offset:12288
    ds_read_b128 a[244:247], v38 offset:28672
    v_lshrrev_b32 v23, 4, v0
    s_lshl_b32 s11, s2, 11
    v_lshl_add_u32 v23, v23, 7, s11
    v_mfma_f32_32x32x16_bf16 v[160:175], v[152:155], a[216:219], v[160:175]
    ds_read_b64_tr_b16 v[136:137], v5 offset:36864
    ds_read_b64_tr_b16 v[138:139], v5 offset:37376
    ds_read_b128 a[248:251], v39 offset:12288
    ds_read_b128 a[252:255], v39 offset:28672
    global_load_dword v54, v23, s[20:21]
    v_mfma_f32_32x32x16_bf16 v[176:191], v[152:155], a[220:223], v[176:191]
    buffer_load_dwordx4 v41, s[36:39], s74 offen offset:1024  lds
    v_mfma_f32_16x16x32_bf16 v[116:119], v[112:115], v[152:155], v[116:119]
    v_mfma_f32_32x32x16_bf16 v[192:207], v[156:159], a[216:219], v[192:207]
    ds_read_b64_tr_b16 v[140:141], v6 offset:36864
    ds_read_b64_tr_b16 v[142:143], v6 offset:37376
    buffer_store_dwordx4 v[68:71], v1, s[48:51], s63 offen offset:1024 sc1
    v_mfma_f32_32x32x16_bf16 v[208:223], v[156:159], a[220:223], v[208:223]
    s_waitcnt lgkmcnt(10)
    buffer_load_dwordx4 v42, s[36:39], s74 offen offset:2048  lds
    s_waitcnt vmcnt(15)
    v_cmp_ne_u32 s[96:97], s83, v58
    v_cmp_ne_u32 vcc, s83, v62
    s_nop 0
    s_or_b64 vcc, vcc, s[96:97]
    s_cbranch_vccnz L_ps_slow
L_ps_ok:
    v_mfma_f32_32x32x16_bf16 v[160:175], v[128:131], a[224:227], v[160:175]
    ds_read_b64_tr_b16 v[144:145], v5 offset:40960
    ds_read_b64_tr_b16 v[146:147], v5 offset:41472
    v_cvt_pk_bf16_f32 v58, v56, v56
    v_rsq_f32 v20, v57
    v_lshlrev_b32 v59, 16, v58
    v_mfma_f32_32x32x16_bf16 v[176:191], v[128:131], a[228:231], v[176:191]
    buffer_load_dwordx4 v43, s[36:39], s74 offen offset:3072  lds
    v_mov_b32 v21, v57
    v_cmp_gt_u32 vcc, 512, v1
    v_sub_f32 v59, v56, v59
    v_mfma_f32_16x16x32_bf16 v[116:119], v[112:115], v[128:131], v[116:119]
    v_mfma_f32_32x32x16_bf16 v[192:207], v[132:135], a[224:227], v[192:207]
    ds_read_b64_tr_b16 v[148:149], v6 offset:40960
    ds_read_b64_tr_b16 v[150:151], v6 offset:41472
    v_mul_f32 v20, 0xbfb8aa3b, v20
    v_cvt_pk_bf16_f32 v59, v59, v59
    v_cndmask_b32 v104, v59, v58, vcc
    v_cvt_pk_bf16_f32 v62, v60, v60
    v_mfma_f32_32x32x16_bf16 v[208:223], v[132:135], a[228:231], v[208:223]
    s_waitcnt lgkmcnt(4)
    v_rsq_f32 v7, v61
    v_lshlrev_b32 v63, 16, v62
    v_mov_b32 v8, v61
    v_mfma_f32_32x32x16_bf16 v[160:175], v[136:139], a[232:235], v[160:175]
    ds_read_b64_tr_b16 v[152:153], v5 offset:45056
    ds_read_b64_tr_b16 v[154:155], v5 offset:45568
    v_cmp_gt_u32 vcc, 512, v1
    s_waitcnt lgkmcnt(4)
    v_mfma_f32_16x16x32_bf16 v[116:119], v[112:115], v[144:147], v[116:119]
    v_mfma_f32_32x32x16_bf16 v[176:191], v[136:139], a[236:239], v[176:191]
    v_sub_f32 v63, v60, v63
    v_mul_f32 v7, 0xbfb8aa3b, v7
    v_cvt_pk_bf16_f32 v63, v63, v63
    v_cndmask_b32 v108, v63, v62, vcc
    v_mfma_f32_16x16x32_bf16 v[116:119], v[112:115], v[136:139], v[116:119]
    v_mfma_f32_32x32x16_bf16 v[192:207], v[140:143], a[232:235], v[192:207]
    ds_read_b64_tr_b16 v[156:157], v6 offset:45056
    ds_read_b64_tr_b16 v[158:159], v6 offset:45568
    v_mfma_f32_32x32x16_bf16 v[208:223], v[140:143], a[236:239], v[208:223]
    s_waitcnt lgkmcnt(4)
    v_mfma_f32_32x32x16_bf16 v[160:175], v[144:147], a[240:243], v[160:175]
    s_barrier
    ds_read_b64_tr_b16 v[128:129], v9 offset:49152
    ds_read_b64_tr_b16 v[130:131], v9 offset:49664
    s_waitcnt lgkmcnt(4)
    v_mfma_f32_16x16x32_bf16 v[116:119], v[112:115], v[152:155], v[116:119]
    v_mfma_f32_32x32x16_bf16 v[176:191], v[144:147], a[244:247], v[176:191]
    s_add_u32 m0, s101, 16384
    s_nop 0
    buffer_load_dwordx4 v40, s[36:39], s75 offen offset:0  lds
    v_mfma_f32_32x32x16_bf16 v[192:207], v[148:151], a[240:243], v[192:207]
    ds_read_b64_tr_b16 v[132:133], v9 offset:51200
    ds_read_b64_tr_b16 v[134:135], v9 offset:51712
    v_and_b32 v29, 256, v1
    v_cmp_eq_u32 vcc, 0, v29
    s_nop 3
    v_cndmask_b32 v96, v117, v116, vcc
    v_mfma_f32_32x32x16_bf16 v[208:223], v[148:151], a[244:247], v[208:223]
    s_waitcnt lgkmcnt(4)
    buffer_load_dwordx4 v41, s[36:39], s75 offen offset:1024  lds
    v_cvt_pk_bf16_f32 v29, v96, v96
    v_lshlrev_b32 v29, 16, v29
    v_sub_f32 v29, v96, v29
    v_cvt_pk_bf16_f32 v96, v96, v29
    ds_write_b32 v124, v96 offset:50176
    v_mfma_f32_32x32x16_bf16 v[160:175], v[152:155], a[248:251], v[160:175]
    ds_read_b64_tr_b16 v[136:137], v9 offset:53248
    ds_read_b64_tr_b16 v[138:139], v9 offset:53760
    s_waitcnt lgkmcnt(2)
    s_barrier
    ds_read_b32 v100, v125 offset:50176
    v_mfma_f32_32x32x16_bf16 v[176:191], v[152:155], a[252:255], v[176:191]
    buffer_load_dwordx4 v42, s[36:39], s75 offen offset:2048  lds
    v_mfma_f32_32x32x16_bf16 v[160:175], v[96:99], v[104:107], v[160:175]
    v_mfma_f32_32x32x16_bf16 v[192:207], v[156:159], a[248:251], v[192:207]
    ds_read_b64_tr_b16 v[140:141], v9 offset:55296
    ds_read_b64_tr_b16 v[142:143], v9 offset:55808
    v_mfma_f32_32x32x16_bf16 v[176:191], v[96:99], v[108:111], v[176:191]
    v_mfma_f32_32x32x16_bf16 v[208:223], v[156:159], a[252:255], v[208:223]
    buffer_load_dwordx4 v43, s[36:39], s75 offen offset:3072  lds
    s_waitcnt lgkmcnt(2)
    v_mfma_f32_32x32x16_bf16 v[192:207], v[100:103], v[104:107], v[192:207]
    s_cmp_eq_u32 s99, 0
    s_cbranch_scc1 L_p2B
    v_mfma_f32_32x32x16_bf16 v[224:239], v[128:131], a[0:3], 0
    ds_read_b64_tr_b16 v[144:145], v9 offset:57344
    ds_read_b64_tr_b16 v[146:147], v9 offset:57856
    v_mfma_f32_32x32x16_bf16 v[208:223], v[100:103], v[108:111], v[208:223]
    v_mfma_f32_32x32x16_bf16 v[240:255], v[128:131], a[4:7], 0
    s_add_u32 m0, s101, 147456
    s_lshl4_add_u32 s92, s60, s76
    buffer_load_dwordx4 v17, s[52:55], s92 offen offset:0 lds
    v_mul_f32 v24, v20, v160
    v_mul_f32 v25, v20, v161
    v_mul_f32 v26, v20, v162
    v_mfma_f32_16x16x32_bf16 v[116:119], v[112:115], v[128:131], 0
    v_mfma_f32_32x32x16_bf16 v[224:239], v[132:135], a[8:11], v[224:239]
    ds_read_b64_tr_b16 v[148:149], v9 offset:59392
    ds_read_b64_tr_b16 v[150:151], v9 offset:59904
    v_mul_f32 v27, v20, v163
    v_exp_f32 v24, v24
    v_exp_f32 v25, v25
    v_exp_f32 v26, v26
    v_mfma_f32_32x32x16_bf16 v[240:255], v[132:135], a[12:15], v[240:255]
    s_waitcnt lgkmcnt(4)
    buffer_load_dwordx4 v18, s[52:55], s92 offen offset:1024 lds
    v_exp_f32 v27, v27
    v_mul_f32 v168, v168, v160
    v_mfma_f32_16x16x32_bf16 v[116:119], v[112:115], v[132:135], v[116:119]
    v_mfma_f32_32x32x16_bf16 v[224:239], v[136:139], a[16:19], v[224:239]
    ds_read_b64_tr_b16 v[152:153], v9 offset:61440
    ds_read_b64_tr_b16 v[154:155], v9 offset:61952
    v_mul_f32 v169, v169, v161
    v_mul_f32 v170, v170, v162
    v_mul_f32 v171, v171, v163
    v_fma_f32 v24, v24, v21, v21
    v_fma_f32 v25, v25, v21, v21
    v_fma_f32 v26, v26, v21, v21
    v_mfma_f32_32x32x16_bf16 v[240:255], v[136:139], a[20:23], v[240:255]
    s_add_u32 m0, s101, 149504
    s_add_u32 s92, s92, 16384
    buffer_load_dwordx4 v17, s[52:55], s92 offen offset:0 lds
    v_fma_f32 v27, v27, v21, v21
    v_rcp_f32 v24, v24
    v_mfma_f32_16x16x32_bf16 v[116:119], v[112:115], v[136:139], v[116:119]
    v_mfma_f32_32x32x16_bf16 v[224:239], v[140:143], a[24:27], v[224:239]
    ds_read_b64_tr_b16 v[156:157], v9 offset:63488
    ds_read_b64_tr_b16 v[158:159], v9 offset:64000
    v_rcp_f32 v25, v25
    v_rcp_f32 v26, v26
    v_rcp_f32 v27, v27
    v_mfma_f32_32x32x16_bf16 v[240:255], v[140:143], a[28:31], v[240:255]
    s_waitcnt lgkmcnt(4)
    buffer_load_dwordx4 v18, s[52:55], s92 offen offset:1024 lds
    v_mul_f32 v168, v168, v24
    v_mul_f32 v169, v169, v25
    v_mul_f32 v170, v170, v26
    v_add_u32 v9, 65536, v9
    v_mfma_f32_16x16x32_bf16 v[116:119], v[112:115], v[140:143], v[116:119]
    v_mfma_f32_32x32x16_bf16 v[224:239], v[144:147], a[32:35], v[224:239]
    s_waitcnt vmcnt(16)
    s_barrier
    ds_read_b64_tr_b16 v[128:129], v9 offset:0
    ds_read_b64_tr_b16 v[130:131], v9 offset:512
    v_mul_f32 v171, v171, v27
    v_cvt_pk_bf16_f32 v160, v168, v169
    v_cvt_pk_bf16_f32 v161, v170, v171
    v_mul_f32 v24, v20, v164
    v_mfma_f32_32x32x16_bf16 v[240:255], v[144:147], a[36:39], v[240:255]
    s_add_u32 m0, s101, 32768
    s_mul_i32 s91, s64, 3584
    buffer_load_dwordx4 v44, s[40:43], s91 offen offset:0  lds
    v_mul_f32 v25, v20, v165
    v_mul_f32 v26, v20, v166
    v_mul_f32 v27, v20, v167
    v_mfma_f32_16x16x32_bf16 v[116:119], v[112:115], v[144:147], v[116:119]
    v_mfma_f32_32x32x16_bf16 v[224:239], v[148:151], a[40:43], v[224:239]
    ds_read_b64_tr_b16 v[132:133], v9 offset:2048
    ds_read_b64_tr_b16 v[134:135], v9 offset:2560
    v_exp_f32 v24, v24
    v_exp_f32 v25, v25
    v_exp_f32 v26, v26
    v_mfma_f32_32x32x16_bf16 v[240:255], v[148:151], a[44:47], v[240:255]
    s_waitcnt lgkmcnt(4)
    buffer_load_dwordx4 v45, s[40:43], s91 offen offset:1024  lds
    v_exp_f32 v27, v27
    v_mul_f32 v172, v172, v164
    v_mul_f32 v173, v173, v165
    v_mul_f32 v174, v174, v166
    v_mfma_f32_16x16x32_bf16 v[116:119], v[112:115], v[148:151], v[116:119]
    v_mfma_f32_32x32x16_bf16 v[224:239], v[152:155], a[48:51], v[224:239]
    ds_read_b64_tr_b16 v[136:137], v9 offset:4096
    ds_read_b64_tr_b16 v[138:139], v9 offset:4608
    v_mul_f32 v175, v175, v167
    v_fma_f32 v24, v24, v21, v21
    v_fma_f32 v25, v25, v21, v21
    v_fma_f32 v26, v26, v21, v21
    v_fma_f32 v27, v27, v21, v21
    v_mfma_f32_32x32x16_bf16 v[240:255], v[152:155], a[52:55], v[240:255]
    buffer_load_dwordx4 v46, s[44:47], s91 offen offset:2048  lds
    v_rcp_f32 v24, v24
    v_rcp_f32 v25, v25
    v_rcp_f32 v26, v26
    v_mfma_f32_16x16x32_bf16 v[116:119], v[112:115], v[152:155], v[116:119]
    v_mfma_f32_32x32x16_bf16 v[224:239], v[156:159], a[56:59], v[224:239]
    ds_read_b64_tr_b16 v[140:141], v9 offset:6144
    ds_read_b64_tr_b16 v[142:143], v9 offset:6656
    v_rcp_f32 v27, v27
    v_mul_f32 v172, v172, v24
    v_mul_f32 v173, v173, v25
    v_mul_f32 v174, v174, v26
    v_mul_f32 v175, v175, v27
    v_mfma_f32_32x32x16_bf16 v[240:255], v[156:159], a[60:63], v[240:255]
    s_waitcnt lgkmcnt(4)
    buffer_load_dwordx4 v47, s[44:47], s91 offen offset:3072  lds
    v_cvt_pk_bf16_f32 v162, v172, v173
    v_cvt_pk_bf16_f32 v163, v174, v175
    s_xor_b32 s95, s87, 0
    buffer_store_dwordx4 v[160:163], v1, s[48:51], s95 offen sc1
    v_mfma_f32_16x16x32_bf16 v[116:119], v[112:115], v[156:159], v[116:119]
    v_mfma_f32_32x32x16_bf16 v[224:239], v[128:131], a[64:67], v[224:239]
    ds_read_b64_tr_b16 v[144:145], v9 offset:8192
    ds_read_b64_tr_b16 v[146:147], v9 offset:8704
    v_mul_f32 v24, v7, v176
    v_mul_f32 v25, v7, v177
    v_mul_f32 v26, v7, v178
    v_mul_f32 v27, v7, v179
    v_exp_f32 v24, v24
    v_mfma_f32_32x32x16_bf16 v[240:255], v[128:131], a[68:71], v[240:255]
    s_lshl2_add_u32 m0, s101, 86016
    s_lshl4_add_u32 s92, s60, s76
    s_add_u32 s92, s92, 32768
    buffer_load_dwordx4 v17, s[52:55], s92 offen offset:0 lds
    v_exp_f32 v25, v25
    v_mfma_f32_16x16x32_bf16 v[116:119], v[112:115], v[128:131], v[116:119]
    v_mfma_f32_32x32x16_bf16 v[224:239], v[132:135], a[72:75], v[224:239]
    ds_read_b64_tr_b16 v[148:149], v9 offset:10240
    ds_read_b64_tr_b16 v[150:151], v9 offset:10752
    v_exp_f32 v26, v26
    v_exp_f32 v27, v27
    v_mul_f32 v184, v184, v176
    v_mul_f32 v185, v185, v177
    v_mfma_f32_32x32x16_bf16 v[240:255], v[132:135], a[76:79], v[240:255]
    s_waitcnt lgkmcnt(4)
    buffer_load_dwordx4 v18, s[52:55], s92 offen offset:1024 lds
    v_mul_f32 v186, v186, v178
    v_mul_f32 v187, v187, v179
    v_fma_f32 v24, v24, v8, v8
    v_fma_f32 v25, v25, v8, v8
    v_mfma_f32_16x16x32_bf16 v[116:119], v[112:115], v[132:135], v[116:119]
    v_mfma_f32_32x32x16_bf16 v[224:239], v[136:139], a[80:83], v[224:239]
    ds_read_b64_tr_b16 v[152:153], v9 offset:12288
    ds_read_b64_tr_b16 v[154:155], v9 offset:12800
    v_fma_f32 v26, v26, v8, v8
    v_fma_f32 v27, v27, v8, v8
    v_rcp_f32 v24, v24
    v_rcp_f32 v25, v25
    v_mfma_f32_32x32x16_bf16 v[240:255], v[136:139], a[84:87], v[240:255]
    s_lshl2_add_u32 m0, s101, 88064
    s_add_u32 s92, s92, 16384
    buffer_load_dwordx4 v17, s[52:55], s92 offen offset:0 lds
    v_rcp_f32 v26, v26
    v_rcp_f32 v27, v27
    v_mfma_f32_16x16x32_bf16 v[116:119], v[112:115], v[136:139], v[116:119]
    v_mfma_f32_32x32x16_bf16 v[224:239], v[140:143], a[88:91], v[224:239]
    ds_read_b64_tr_b16 v[156:157], v9 offset:14336
    ds_read_b64_tr_b16 v[158:159], v9 offset:14848
    v_mul_f32 v184, v184, v24
    v_mul_f32 v185, v185, v25
    v_mul_f32 v186, v186, v26
    v_mul_f32 v187, v187, v27
    v_cvt_pk_bf16_f32 v176, v184, v185
    v_mfma_f32_32x32x16_bf16 v[240:255], v[140:143], a[92:95], v[240:255]
    s_waitcnt lgkmcnt(4)
    buffer_load_dwordx4 v18, s[52:55], s92 offen offset:1024 lds
    v_cvt_pk_bf16_f32 v177, v186, v187
    v_mul_f32 v24, v7, v180
    v_mul_f32 v25, v7, v181
    v_subrev_u32 v9, 65536, v9
    v_mfma_f32_16x16x32_bf16 v[116:119], v[112:115], v[140:143], v[116:119]
    v_mfma_f32_32x32x16_bf16 v[224:239], v[144:147], a[96:99], v[224:239]
    s_waitcnt vmcnt(17)
    s_barrier
    ds_read_b64_tr_b16 v[128:129], v9 offset:0
    ds_read_b64_tr_b16 v[130:131], v9 offset:512
    v_mul_f32 v26, v7, v182
    v_mul_f32 v27, v7, v183
    v_exp_f32 v24, v24
    v_mfma_f32_32x32x16_bf16 v[240:255], v[144:147], a[100:103], v[240:255]
    s_add_u32 m0, s101, 49152
    s_mul_i32 s91, s65, 3584
    buffer_load_dwordx4 v44, s[40:43], s91 offen offset:0  lds
    v_exp_f32 v25, v25
    v_exp_f32 v26, v26
    v_mfma_f32_16x16x32_bf16 v[116:119], v[112:115], v[144:147], v[116:119]
    v_mfma_f32_32x32x16_bf16 v[224:239], v[148:151], a[104:107], v[224:239]
    ds_read_b64_tr_b16 v[132:133], v9 offset:2048
    ds_read_b64_tr_b16 v[134:135], v9 offset:2560
    v_exp_f32 v27, v27
    v_mul_f32 v188, v188, v180
    v_mul_f32 v189, v189, v181
    v_mul_f32 v190, v190, v182
    v_mfma_f32_32x32x16_bf16 v[240:255], v[148:151], a[108:111], v[240:255]
    s_waitcnt lgkmcnt(4)
    buffer_load_dwordx4 v45, s[40:43], s91 offen offset:1024  lds
    v_mul_f32 v191, v191, v183
    v_fma_f32 v24, v24, v8, v8
    v_fma_f32 v25, v25, v8, v8
    v_fma_f32 v26, v26, v8, v8
    v_mfma_f32_16x16x32_bf16 v[116:119], v[112:115], v[148:151], v[116:119]
    v_mfma_f32_32x32x16_bf16 v[224:239], v[152:155], a[112:115], v[224:239]
    ds_read_b64_tr_b16 v[136:137], v9 offset:4096
    ds_read_b64_tr_b16 v[138:139], v9 offset:4608
    v_fma_f32 v27, v27, v8, v8
    v_rcp_f32 v24, v24
    v_rcp_f32 v25, v25
    v_rcp_f32 v26, v26
    v_mfma_f32_32x32x16_bf16 v[240:255], v[152:155], a[116:119], v[240:255]
    buffer_load_dwordx4 v46, s[44:47], s91 offen offset:2048  lds
    v_rcp_f32 v27, v27
    v_mul_f32 v188, v188, v24
    v_mul_f32 v189, v189, v25
    v_mfma_f32_16x16x32_bf16 v[116:119], v[112:115], v[152:155], v[116:119]
    v_mfma_f32_32x32x16_bf16 v[224:239], v[156:159], a[120:123], v[224:239]
    ds_read_b64_tr_b16 v[140:141], v9 offset:6144
    ds_read_b64_tr_b16 v[142:143], v9 offset:6656
    v_mul_f32 v190, v190, v26
    v_mul_f32 v191, v191, v27
    v_cvt_pk_bf16_f32 v178, v188, v189
    v_cvt_pk_bf16_f32 v179, v190, v191
    s_xor_b32 s95, s87, 0
    s_add_u32 s95, s95, 147456
    buffer_store_dwordx4 v[176:179], v1, s[48:51], s95 offen sc1
    v_mfma_f32_32x32x16_bf16 v[240:255], v[156:159], a[124:127], v[240:255]
    s_waitcnt lgkmcnt(4)
    buffer_load_dwordx4 v47, s[44:47], s91 offen offset:3072  lds
    v_mul_f32 v24, v20, v192
    v_mul_f32 v25, v20, v193
    v_mul_f32 v26, v20, v194
    v_mfma_f32_16x16x32_bf16 v[116:119], v[112:115], v[156:159], v[116:119]
    v_mfma_f32_32x32x16_bf16 v[224:239], v[128:131], a[128:131], v[224:239]
    ds_read_b64_tr_b16 v[144:145], v9 offset:8192
    ds_read_b64_tr_b16 v[146:147], v9 offset:8704
    v_mul_f32 v27, v20, v195
    v_exp_f32 v24, v24
    v_exp_f32 v25, v25
    v_exp_f32 v26, v26
    v_mfma_f32_32x32x16_bf16 v[240:255], v[128:131], a[132:135], v[240:255]
    s_lshl2_add_u32 m0, s101, 90112
    s_lshl4_add_u32 s92, s61, s76
    buffer_load_dwordx4 v17, s[52:55], s92 offen offset:0 lds
    v_exp_f32 v27, v27
    v_mul_f32 v200, v200, v192
    v_mfma_f32_16x16x32_bf16 v[116:119], v[112:115], v[128:131], v[116:119]
    v_mfma_f32_32x32x16_bf16 v[224:239], v[132:135], a[136:139], v[224:239]
    ds_read_b64_tr_b16 v[148:149], v9 offset:10240
    ds_read_b64_tr_b16 v[150:151], v9 offset:10752
    v_mul_f32 v201, v201, v193
    v_mul_f32 v202, v202, v194
    v_mul_f32 v203, v203, v195
    v_fma_f32 v24, v24, v21, v21
    v_fma_f32 v25, v25, v21, v21
    v_fma_f32 v26, v26, v21, v21
    v_mfma_f32_32x32x16_bf16 v[240:255], v[132:135], a[140:143], v[240:255]
    s_waitcnt lgkmcnt(4)
    buffer_load_dwordx4 v18, s[52:55], s92 offen offset:1024 lds
    v_fma_f32 v27, v27, v21, v21
    v_rcp_f32 v24, v24
    v_mfma_f32_16x16x32_bf16 v[116:119], v[112:115], v[132:135], v[116:119]
    v_mfma_f32_32x32x16_bf16 v[224:239], v[136:139], a[144:147], v[224:239]
    ds_read_b64_tr_b16 v[152:153], v9 offset:12288
    ds_read_b64_tr_b16 v[154:155], v9 offset:12800
    v_rcp_f32 v25, v25
    v_rcp_f32 v26, v26
    v_rcp_f32 v27, v27
    v_mul_f32 v200, v200, v24
    v_mfma_f32_32x32x16_bf16 v[240:255], v[136:139], a[148:151], v[240:255]
    s_lshl2_add_u32 m0, s101, 92160
    s_add_u32 s92, s92, 16384
    buffer_load_dwordx4 v17, s[52:55], s92 offen offset:0 lds
    v_mul_f32 v201, v201, v25
    v_mul_f32 v202, v202, v26
    v_mul_f32 v203, v203, v27
    v_mfma_f32_16x16x32_bf16 v[116:119], v[112:115], v[136:139], v[116:119]
    v_mfma_f32_32x32x16_bf16 v[224:239], v[140:143], a[152:155], v[224:239]
    ds_read_b64_tr_b16 v[156:157], v9 offset:14336
    ds_read_b64_tr_b16 v[158:159], v9 offset:14848
    v_cvt_pk_bf16_f32 v192, v200, v201
    v_cvt_pk_bf16_f32 v193, v202, v203
    v_mul_f32 v24, v20, v196
    v_mul_f32 v25, v20, v197
    v_mul_f32 v26, v20, v198
    v_mul_f32 v27, v20, v199
    v_mfma_f32_32x32x16_bf16 v[240:255], v[140:143], a[156:159], v[240:255]
    s_waitcnt lgkmcnt(4)
    buffer_load_dwordx4 v18, s[52:55], s92 offen offset:1024 lds
    v_exp_f32 v24, v24
    v_exp_f32 v25, v25
    v_mfma_f32_16x16x32_bf16 v[116:119], v[112:115], v[140:143], v[116:119]
    v_mfma_f32_32x32x16_bf16 v[224:239], v[144:147], a[160:163], v[224:239]
    s_waitcnt vmcnt(22)
    s_barrier
    ds_read_b64_tr_b16 v[128:129], v9 offset:16384
    ds_read_b64_tr_b16 v[130:131], v9 offset:16896
    v_exp_f32 v26, v26
    v_exp_f32 v27, v27
    v_mfma_f32_32x32x16_bf16 v[240:255], v[144:147], a[164:167], v[240:255]
    s_add_u32 m0, s101, 65536
    s_mul_i32 s91, s66, 3584
    buffer_load_dwordx4 v44, s[40:43], s91 offen offset:0  lds
    v_mul_f32 v204, v204, v196
    v_mul_f32 v205, v205, v197
    v_mul_f32 v206, v206, v198
    v_mfma_f32_16x16x32_bf16 v[116:119], v[112:115], v[144:147], v[116:119]
    v_mfma_f32_32x32x16_bf16 v[224:239], v[148:151], a[168:171], v[224:239]
    ds_read_b64_tr_b16 v[132:133], v9 offset:18432
    ds_read_b64_tr_b16 v[134:135], v9 offset:18944
    v_mul_f32 v207, v207, v199
    v_fma_f32 v24, v24, v21, v21
    v_fma_f32 v25, v25, v21, v21
    v_fma_f32 v26, v26, v21, v21
    v_fma_f32 v27, v27, v21, v21
    v_rcp_f32 v24, v24
    v_mfma_f32_32x32x16_bf16 v[240:255], v[148:151], a[172:175], v[240:255]
    s_waitcnt lgkmcnt(4)
    buffer_load_dwordx4 v45, s[40:43], s91 offen offset:1024  lds
    v_rcp_f32 v25, v25
    v_rcp_f32 v26, v26
    v_mfma_f32_16x16x32_bf16 v[116:119], v[112:115], v[148:151], v[116:119]
    v_mfma_f32_32x32x16_bf16 v[224:239], v[152:155], a[176:179], v[224:239]
    ds_read_b64_tr_b16 v[136:137], v9 offset:20480
    ds_read_b64_tr_b16 v[138:139], v9 offset:20992
    v_rcp_f32 v27, v27
    v_mul_f32 v204, v204, v24
    v_mul_f32 v205, v205, v25
    v_mul_f32 v206, v206, v26
    v_mfma_f32_32x32x16_bf16 v[240:255], v[152:155], a[180:183], v[240:255]
    buffer_load_dwordx4 v46, s[44:47], s91 offen offset:2048  lds
    v_mul_f32 v207, v207, v27
    v_cvt_pk_bf16_f32 v194, v204, v205
    v_cvt_pk_bf16_f32 v195, v206, v207
    s_xor_b32 s95, s87, 1024
    buffer_store_dwordx4 v[192:195], v1, s[48:51], s95 offen sc1
    v_mfma_f32_16x16x32_bf16 v[116:119], v[112:115], v[152:155], v[116:119]
    v_mfma_f32_32x32x16_bf16 v[224:239], v[156:159], a[184:187], v[224:239]
    ds_read_b64_tr_b16 v[140:141], v9 offset:22528
    ds_read_b64_tr_b16 v[142:143], v9 offset:23040
    v_mul_f32 v24, v7, v208
    v_mul_f32 v25, v7, v209
    v_mul_f32 v26, v7, v210
    v_mul_f32 v27, v7, v211
    v_exp_f32 v24, v24
    v_mfma_f32_32x32x16_bf16 v[240:255], v[156:159], a[188:191], v[240:255]
    s_waitcnt lgkmcnt(4)
    buffer_load_dwordx4 v47, s[44:47], s91 offen offset:3072  lds
    v_exp_f32 v25, v25
    v_exp_f32 v26, v26
    v_mfma_f32_16x16x32_bf16 v[116:119], v[112:115], v[156:159], v[116:119]
    v_mfma_f32_32x32x16_bf16 v[224:239], v[128:131], a[192:195], v[224:239]
    ds_read_b64_tr_b16 v[144:145], v9 offset:24576
    ds_read_b64_tr_b16 v[146:147], v9 offset:25088
    v_exp_f32 v27, v27
    v_mul_f32 v216, v216, v208
    v_mul_f32 v217, v217, v209
    v_mul_f32 v218, v218, v210
    v_mul_f32 v219, v219, v211
    v_mfma_f32_32x32x16_bf16 v[240:255], v[128:131], a[196:199], v[240:255]
    s_lshl2_add_u32 m0, s101, 94208
    s_lshl4_add_u32 s92, s61, s76
    s_add_u32 s92, s92, 32768
    buffer_load_dwordx4 v17, s[52:55], s92 offen offset:0 lds
    v_fma_f32 v24, v24, v8, v8
    v_fma_f32 v25, v25, v8, v8
    v_mfma_f32_16x16x32_bf16 v[116:119], v[112:115], v[128:131], v[116:119]
    v_mfma_f32_32x32x16_bf16 v[224:239], v[132:135], a[200:203], v[224:239]
    ds_read_b64_tr_b16 v[148:149], v9 offset:26624
    ds_read_b64_tr_b16 v[150:151], v9 offset:27136
    v_fma_f32 v26, v26, v8, v8
    v_fma_f32 v27, v27, v8, v8
    v_rcp_f32 v24, v24
    v_rcp_f32 v25, v25
    v_mfma_f32_32x32x16_bf16 v[240:255], v[132:135], a[204:207], v[240:255]
    s_waitcnt lgkmcnt(4)
    buffer_load_dwordx4 v18, s[52:55], s92 offen offset:1024 lds
    v_rcp_f32 v26, v26
    v_rcp_f32 v27, v27
    v_mfma_f32_16x16x32_bf16 v[116:119], v[112:115], v[132:135], v[116:119]
    v_mfma_f32_32x32x16_bf16 v[224:239], v[136:139], a[208:211], v[224:239]
    ds_read_b64_tr_b16 v[152:153], v9 offset:28672
    ds_read_b64_tr_b16 v[154:155], v9 offset:29184
    v_mul_f32 v216, v216, v24
    v_mul_f32 v217, v217, v25
    v_mul_f32 v218, v218, v26
    v_mul_f32 v219, v219, v27
    v_cvt_pk_bf16_f32 v208, v216, v217
    v_cvt_pk_bf16_f32 v209, v218, v219
    v_mul_f32 v24, v7, v212
    v_mfma_f32_32x32x16_bf16 v[240:255], v[136:139], a[212:215], v[240:255]
    s_lshl2_add_u32 m0, s101, 96256
    s_add_u32 s92, s92, 16384
    buffer_load_dwordx4 v17, s[52:55], s92 offen offset:0 lds
    v_mul_f32 v25, v7, v213
    v_mul_f32 v26, v7, v214
    v_mul_f32 v27, v7, v215
    v_mfma_f32_16x16x32_bf16 v[116:119], v[112:115], v[136:139], v[116:119]
    v_mfma_f32_32x32x16_bf16 v[224:239], v[140:143], a[216:219], v[224:239]
    ds_read_b64_tr_b16 v[156:157], v9 offset:30720
    ds_read_b64_tr_b16 v[158:159], v9 offset:31232
    v_exp_f32 v24, v24
    v_exp_f32 v25, v25
    v_exp_f32 v26, v26
    v_mfma_f32_32x32x16_bf16 v[240:255], v[140:143], a[220:223], v[240:255]
    s_waitcnt lgkmcnt(4)
    buffer_load_dwordx4 v18, s[52:55], s92 offen offset:1024 lds
    v_exp_f32 v27, v27
    v_mul_f32 v220, v220, v212
    v_mul_f32 v221, v221, v213
    v_mfma_f32_16x16x32_bf16 v[116:119], v[112:115], v[140:143], v[116:119]
    v_mfma_f32_32x32x16_bf16 v[224:239], v[144:147], a[224:227], v[224:239]
    s_waitcnt vmcnt(23)
    s_barrier
    ds_read_b64_tr_b16 v[128:129], v5 offset:32768
    ds_read_b64_tr_b16 v[130:131], v5 offset:33280
    v_mul_f32 v222, v222, v214
    v_mul_f32 v223, v223, v215
    s_waitcnt lgkmcnt(4)
    v_mfma_f32_16x16x32_bf16 v[116:119], v[112:115], v[152:155], v[116:119]
    v_mfma_f32_32x32x16_bf16 v[240:255], v[144:147], a[228:231], v[240:255]
    s_add_u32 m0, s101, 0
    s_mul_i32 s91, s67, 3584
    buffer_load_dwordx4 v44, s[40:43], s91 offen offset:0  lds
    v_fma_f32 v24, v24, v8, v8
    v_fma_f32 v25, v25, v8, v8
    v_fma_f32 v26, v26, v8, v8
    v_mfma_f32_16x16x32_bf16 v[116:119], v[112:115], v[144:147], v[116:119]
    v_mfma_f32_32x32x16_bf16 v[224:239], v[148:151], a[232:235], v[224:239]
    ds_read_b64_tr_b16 v[132:133], v6 offset:32768
    ds_read_b64_tr_b16 v[134:135], v6 offset:33280
    v_fma_f32 v27, v27, v8, v8
    v_rcp_f32 v24, v24
    s_waitcnt lgkmcnt(4)
    v_mfma_f32_16x16x32_bf16 v[116:119], v[112:115], v[156:159], v[116:119]
    v_mfma_f32_32x32x16_bf16 v[240:255], v[148:151], a[236:239], v[240:255]
    buffer_load_dwordx4 v45, s[40:43], s91 offen offset:1024  lds
    v_rcp_f32 v25, v25
    v_rcp_f32 v26, v26
    v_mfma_f32_16x16x32_bf16 v[116:119], v[112:115], v[148:151], v[116:119]
    v_mfma_f32_32x32x16_bf16 v[224:239], v[152:155], a[240:243], v[224:239]
    ds_read_b64_tr_b16 v[136:137], v5 offset:36864
    ds_read_b64_tr_b16 v[138:139], v5 offset:37376
    v_and_b32 v29, 256, v1
    v_cmp_eq_u32 vcc, 0, v29
    s_nop 3
    v_cndmask_b32 v96, v117, v116, vcc
    v_rcp_f32 v27, v27
    v_mfma_f32_32x32x16_bf16 v[240:255], v[152:155], a[244:247], v[240:255]
    buffer_load_dwordx4 v46, s[44:47], s91 offen offset:2048  lds
    v_cvt_pk_bf16_f32 v29, v96, v96
    v_lshlrev_b32 v29, 16, v29
    v_sub_f32 v29, v96, v29
    v_cvt_pk_bf16_f32 v96, v96, v29
    v_mul_f32 v220, v220, v24
    v_mul_f32 v221, v221, v25
    v_mul_f32 v222, v222, v26
    v_mfma_f32_32x32x16_bf16 v[224:239], v[156:159], a[248:251], v[224:239]
    ds_read_b64_tr_b16 v[140:141], v6 offset:36864
    ds_read_b64_tr_b16 v[142:143], v6 offset:37376
    v_mul_f32 v223, v223, v27
    v_cvt_pk_bf16_f32 v210, v220, v221
    v_cvt_pk_bf16_f32 v211, v222, v223
    s_xor_b32 s95, s87, 1024
    s_add_u32 s95, s95, 147456
    buffer_store_dwordx4 v[208:211], v1, s[48:51], s95 offen sc1
    v_mfma_f32_32x32x16_bf16 v[240:255], v[156:159], a[252:255], v[240:255]
    s_waitcnt lgkmcnt(4)
    buffer_load_dwordx4 v47, s[44:47], s91 offen offset:3072  lds
    v_mfma_f32_32x32x16_bf16 v[224:239], v[96:99], v[104:107], v[224:239]
    s_branch L_p3
L_p2B:
    v_mfma_f32_32x32x16_bf16 v[224:239], v[128:131], a[0:3], 0
    ds_read_b64_tr_b16 v[144:145], v9 offset:57344
    ds_read_b64_tr_b16 v[146:147], v9 offset:57856
    v_mfma_f32_32x32x16_bf16 v[208:223], v[100:103], v[108:111], v[208:223]
    v_mfma_f32_32x32x16_bf16 v[240:255], v[128:131], a[4:7], 0
    s_add_u32 m0, s101, 147456
    s_lshl4_add_u32 s92, s60, s76
    buffer_load_dwordx4 v17, s[52:55], s92 offen offset:0 lds
    v_mul_f32 v24, 0xbf317218, v20
    v_mfma_f32_16x16x32_bf16 v[116:119], v[112:115], v[128:131], 0
    v_mfma_f32_32x32x16_bf16 v[224:239], v[132:135], a[8:11], v[224:239]
    ds_read_b64_tr_b16 v[148:149], v9 offset:59392
    ds_read_b64_tr_b16 v[150:151], v9 offset:59904
    v_mul_f32 v25, 0xbf317218, v7
    v_mul_f32 v160, v24, v160
    v_mul_f32 v161, v24, v161
    v_mfma_f32_32x32x16_bf16 v[240:255], v[132:135], a[12:15], v[240:255]
    s_waitcnt lgkmcnt(4)
    buffer_load_dwordx4 v18, s[52:55], s92 offen offset:1024 lds
    v_mul_f32 v162, v24, v162
    v_mul_f32 v163, v24, v163
    v_mfma_f32_16x16x32_bf16 v[116:119], v[112:115], v[132:135], v[116:119]
    v_mfma_f32_32x32x16_bf16 v[224:239], v[136:139], a[16:19], v[224:239]
    ds_read_b64_tr_b16 v[152:153], v9 offset:61440
    ds_read_b64_tr_b16 v[154:155], v9 offset:61952
    v_mul_f32 v164, v24, v164
    v_mul_f32 v165, v24, v165
    v_mul_f32 v166, v24, v166
    v_mfma_f32_32x32x16_bf16 v[240:255], v[136:139], a[20:23], v[240:255]
    s_add_u32 m0, s101, 149504
    s_add_u32 s92, s92, 16384
    buffer_load_dwordx4 v17, s[52:55], s92 offen offset:0 lds
    v_mul_f32 v167, v24, v167
    v_mfma_f32_16x16x32_bf16 v[116:119], v[112:115], v[136:139], v[116:119]
    v_mfma_f32_32x32x16_bf16 v[224:239], v[140:143], a[24:27], v[224:239]
    ds_read_b64_tr_b16 v[156:157], v9 offset:63488
    ds_read_b64_tr_b16 v[158:159], v9 offset:64000
    v_mul_f32 v168, v24, v168
    v_mul_f32 v169, v24, v169
    v_mul_f32 v170, v24, v170
    v_mul_f32 v171, v24, v171
    v_mfma_f32_32x32x16_bf16 v[240:255], v[140:143], a[28:31], v[240:255]
    s_waitcnt lgkmcnt(4)
    buffer_load_dwordx4 v18, s[52:55], s92 offen offset:1024 lds
    v_add_u32 v9, 65536, v9
    v_mfma_f32_16x16x32_bf16 v[116:119], v[112:115], v[140:143], v[116:119]
    v_mfma_f32_32x32x16_bf16 v[224:239], v[144:147], a[32:35], v[224:239]
    s_waitcnt vmcnt(16)
    s_barrier
    ds_read_b64_tr_b16 v[128:129], v9 offset:0
    ds_read_b64_tr_b16 v[130:131], v9 offset:512
    v_mul_f32 v172, v24, v172
    v_mul_f32 v173, v24, v173
    v_mfma_f32_32x32x16_bf16 v[240:255], v[144:147], a[36:39], v[240:255]
    s_add_u32 m0, s101, 32768
    s_mul_i32 s91, s64, 3584
    buffer_load_dwordx4 v44, s[40:43], s91 offen offset:0  lds
    v_mul_f32 v174, v24, v174
    v_mfma_f32_16x16x32_bf16 v[116:119], v[112:115], v[144:147], v[116:119]
    v_mfma_f32_32x32x16_bf16 v[224:239], v[148:151], a[40:43], v[224:239]
    ds_read_b64_tr_b16 v[132:133], v9 offset:2048
    ds_read_b64_tr_b16 v[134:135], v9 offset:2560
    v_mul_f32 v175, v24, v175
    v_cvt_pk_bf16_f32 v160, v160, v161
    v_cvt_pk_bf16_f32 v161, v162, v163
    v_mfma_f32_32x32x16_bf16 v[240:255], v[148:151], a[44:47], v[240:255]
    s_waitcnt lgkmcnt(4)
    buffer_load_dwordx4 v45, s[40:43], s91 offen offset:1024  lds
    v_cvt_pk_bf16_f32 v162, v164, v165
    v_cvt_pk_bf16_f32 v163, v166, v167
    v_mfma_f32_16x16x32_bf16 v[116:119], v[112:115], v[148:151], v[116:119]
    v_mfma_f32_32x32x16_bf16 v[224:239], v[152:155], a[48:51], v[224:239]
    ds_read_b64_tr_b16 v[136:137], v9 offset:4096
    ds_read_b64_tr_b16 v[138:139], v9 offset:4608
    s_xor_b32 s95, s87, 0
    buffer_store_dwordx4 v[160:163], v1, s[48:51], s95 offen sc1
    v_cvt_pk_bf16_f32 v168, v168, v169
    v_mfma_f32_32x32x16_bf16 v[240:255], v[152:155], a[52:55], v[240:255]
    buffer_load_dwordx4 v46, s[44:47], s91 offen offset:2048  lds
    v_cvt_pk_bf16_f32 v169, v170, v171
    v_cvt_pk_bf16_f32 v170, v172, v173
    v_cvt_pk_bf16_f32 v171, v174, v175
    v_mfma_f32_16x16x32_bf16 v[116:119], v[112:115], v[152:155], v[116:119]
    v_mfma_f32_32x32x16_bf16 v[224:239], v[156:159], a[56:59], v[224:239]
    ds_read_b64_tr_b16 v[140:141], v9 offset:6144
    ds_read_b64_tr_b16 v[142:143], v9 offset:6656
    s_xor_b32 s95, s87, 0
    buffer_store_dwordx4 v[168:171], v1, s[48:51], s95 offen offset:2048 sc1
    v_mul_f32 v176, v25, v176
    v_mfma_f32_32x32x16_bf16 v[240:255], v[156:159], a[60:63], v[240:255]
    s_waitcnt lgkmcnt(4)
    buffer_load_dwordx4 v47, s[44:47], s91 offen offset:3072  lds
    v_mul_f32 v177, v25, v177
    v_mul_f32 v178, v25, v178
    v_mfma_f32_16x16x32_bf16 v[116:119], v[112:115], v[156:159], v[116:119]
    v_mfma_f32_32x32x16_bf16 v[224:239], v[128:131], a[64:67], v[224:239]
    ds_read_b64_tr_b16 v[144:145], v9 offset:8192
    ds_read_b64_tr_b16 v[146:147], v9 offset:8704
    v_mul_f32 v179, v25, v179
    v_mul_f32 v180, v25, v180
    v_mul_f32 v181, v25, v181
    v_mul_f32 v182, v25, v182
    v_mfma_f32_32x32x16_bf16 v[240:255], v[128:131], a[68:71], v[240:255]
    s_lshl2_add_u32 m0, s101, 86016
    s_lshl4_add_u32 s92, s60, s76
    s_add_u32 s92, s92, 32768
    buffer_load_dwordx4 v17, s[52:55], s92 offen offset:0 lds
    v_mfma_f32_16x16x32_bf16 v[116:119], v[112:115], v[128:131], v[116:119]
    v_mfma_f32_32x32x16_bf16 v[224:239], v[132:135], a[72:75], v[224:239]
    ds_read_b64_tr_b16 v[148:149], v9 offset:10240
    ds_read_b64_tr_b16 v[150:151], v9 offset:10752
    v_mul_f32 v183, v25, v183
    v_mul_f32 v184, v25, v184
    v_mul_f32 v185, v25, v185
    v_mfma_f32_32x32x16_bf16 v[240:255], v[132:135], a[76:79], v[240:255]
    s_waitcnt lgkmcnt(4)
    buffer_load_dwordx4 v18, s[52:55], s92 offen offset:1024 lds
    v_mul_f32 v186, v25, v186
    v_mul_f32 v187, v25, v187
    v_mfma_f32_16x16x32_bf16 v[116:119], v[112:115], v[132:135], v[116:119]
    v_mfma_f32_32x32x16_bf16 v[224:239], v[136:139], a[80:83], v[224:239]
    ds_read_b64_tr_b16 v[152:153], v9 offset:12288
    ds_read_b64_tr_b16 v[154:155], v9 offset:12800
    v_mul_f32 v188, v25, v188
    v_mul_f32 v189, v25, v189
    v_mul_f32 v190, v25, v190
    v_mfma_f32_32x32x16_bf16 v[240:255], v[136:139], a[84:87], v[240:255]
    s_lshl2_add_u32 m0, s101, 88064
    s_add_u32 s92, s92, 16384
    buffer_load_dwordx4 v17, s[52:55], s92 offen offset:0 lds
    v_mul_f32 v191, v25, v191
    v_mfma_f32_16x16x32_bf16 v[116:119], v[112:115], v[136:139], v[116:119]
    v_mfma_f32_32x32x16_bf16 v[224:239], v[140:143], a[88:91], v[224:239]
    ds_read_b64_tr_b16 v[156:157], v9 offset:14336
    ds_read_b64_tr_b16 v[158:159], v9 offset:14848
    v_cvt_pk_bf16_f32 v176, v176, v177
    v_cvt_pk_bf16_f32 v177, v178, v179
    v_cvt_pk_bf16_f32 v178, v180, v181
    v_mfma_f32_32x32x16_bf16 v[240:255], v[140:143], a[92:95], v[240:255]
    s_waitcnt lgkmcnt(4)
    buffer_load_dwordx4 v18, s[52:55], s92 offen offset:1024 lds
    v_cvt_pk_bf16_f32 v179, v182, v183
    v_subrev_u32 v9, 65536, v9
    v_mfma_f32_16x16x32_bf16 v[116:119], v[112:115], v[140:143], v[116:119]
    v_mfma_f32_32x32x16_bf16 v[224:239], v[144:147], a[96:99], v[224:239]
    s_waitcnt vmcnt(18)
    s_barrier
    ds_read_b64_tr_b16 v[128:129], v9 offset:0
    ds_read_b64_tr_b16 v[130:131], v9 offset:512
    s_xor_b32 s95, s87, 0
    s_add_u32 s95, s95, 65536
    buffer_store_dwordx4 v[176:179], v1, s[48:51], s95 offen sc1
    v_mfma_f32_32x32x16_bf16 v[240:255], v[144:147], a[100:103], v[240:255]
    s_add_u32 m0, s101, 49152
    s_mul_i32 s91, s65, 3584
    buffer_load_dwordx4 v44, s[40:43], s91 offen offset:0  lds
    v_mfma_f32_16x16x32_bf16 v[116:119], v[112:115], v[144:147], v[116:119]
    v_mfma_f32_32x32x16_bf16 v[224:239], v[148:151], a[104:107], v[224:239]
    ds_read_b64_tr_b16 v[132:133], v9 offset:2048
    ds_read_b64_tr_b16 v[134:135], v9 offset:2560
    v_cvt_pk_bf16_f32 v184, v184, v185
    v_cvt_pk_bf16_f32 v185, v186, v187
    v_cvt_pk_bf16_f32 v186, v188, v189
    v_mfma_f32_32x32x16_bf16 v[240:255], v[148:151], a[108:111], v[240:255]
    s_waitcnt lgkmcnt(4)
    buffer_load_dwordx4 v45, s[40:43], s91 offen offset:1024  lds
    v_cvt_pk_bf16_f32 v187, v190, v191
    v_mfma_f32_16x16x32_bf16 v[116:119], v[112:115], v[148:151], v[116:119]
    v_mfma_f32_32x32x16_bf16 v[224:239], v[152:155], a[112:115], v[224:239]
    ds_read_b64_tr_b16 v[136:137], v9 offset:4096
    ds_read_b64_tr_b16 v[138:139], v9 offset:4608
    s_xor_b32 s95, s87, 0
    s_add_u32 s95, s95, 65536
    buffer_store_dwordx4 v[184:187], v1, s[48:51], s95 offen offset:2048 sc1
    v_mul_f32 v192, v24, v192
    v_mfma_f32_32x32x16_bf16 v[240:255], v[152:155], a[116:119], v[240:255]
    buffer_load_dwordx4 v46, s[44:47], s91 offen offset:2048  lds
    v_mul_f32 v193, v24, v193
    v_mul_f32 v194, v24, v194
    v_mul_f32 v195, v24, v195
    v_mfma_f32_16x16x32_bf16 v[116:119], v[112:115], v[152:155], v[116:119]
    v_mfma_f32_32x32x16_bf16 v[224:239], v[156:159], a[120:123], v[224:239]
    ds_read_b64_tr_b16 v[140:141], v9 offset:6144
    ds_read_b64_tr_b16 v[142:143], v9 offset:6656
    v_mul_f32 v196, v24, v196
    v_mul_f32 v197, v24, v197
    v_mul_f32 v198, v24, v198
    v_mfma_f32_32x32x16_bf16 v[240:255], v[156:159], a[124:127], v[240:255]
    s_waitcnt lgkmcnt(4)
    buffer_load_dwordx4 v47, s[44:47], s91 offen offset:3072  lds
    v_mul_f32 v199, v24, v199
    v_mul_f32 v200, v24, v200
    v_mfma_f32_16x16x32_bf16 v[116:119], v[112:115], v[156:159], v[116:119]
    v_mfma_f32_32x32x16_bf16 v[224:239], v[128:131], a[128:131], v[224:239]
    ds_read_b64_tr_b16 v[144:145], v9 offset:8192
    ds_read_b64_tr_b16 v[146:147], v9 offset:8704
    v_mul_f32 v201, v24, v201
    v_mul_f32 v202, v24, v202
    v_mul_f32 v203, v24, v203
    v_mfma_f32_32x32x16_bf16 v[240:255], v[128:131], a[132:135], v[240:255]
    s_lshl2_add_u32 m0, s101, 90112
    s_lshl4_add_u32 s92, s61, s76
    buffer_load_dwordx4 v17, s[52:55], s92 offen offset:0 lds
    v_mul_f32 v204, v24, v204
    v_mfma_f32_16x16x32_bf16 v[116:119], v[112:115], v[128:131], v[116:119]
    v_mfma_f32_32x32x16_bf16 v[224:239], v[132:135], a[136:139], v[224:239]
    ds_read_b64_tr_b16 v[148:149], v9 offset:10240
    ds_read_b64_tr_b16 v[150:151], v9 offset:10752
    v_mul_f32 v205, v24, v205
    v_mul_f32 v206, v24, v206
    v_mul_f32 v207, v24, v207
    v_mfma_f32_32x32x16_bf16 v[240:255], v[132:135], a[140:143], v[240:255]
    s_waitcnt lgkmcnt(4)
    buffer_load_dwordx4 v18, s[52:55], s92 offen offset:1024 lds
    v_cvt_pk_bf16_f32 v192, v192, v193
    v_cvt_pk_bf16_f32 v193, v194, v195
    v_mfma_f32_16x16x32_bf16 v[116:119], v[112:115], v[132:135], v[116:119]
    v_mfma_f32_32x32x16_bf16 v[224:239], v[136:139], a[144:147], v[224:239]
    ds_read_b64_tr_b16 v[152:153], v9 offset:12288
    ds_read_b64_tr_b16 v[154:155], v9 offset:12800
    v_cvt_pk_bf16_f32 v194, v196, v197
    v_cvt_pk_bf16_f32 v195, v198, v199
    s_xor_b32 s95, s87, 1024
    buffer_store_dwordx4 v[192:195], v1, s[48:51], s95 offen sc1
    v_mfma_f32_32x32x16_bf16 v[240:255], v[136:139], a[148:151], v[240:255]
    s_lshl2_add_u32 m0, s101, 92160
    s_add_u32 s92, s92, 16384
    buffer_load_dwordx4 v17, s[52:55], s92 offen offset:0 lds
    v_mfma_f32_16x16x32_bf16 v[116:119], v[112:115], v[136:139], v[116:119]
    v_mfma_f32_32x32x16_bf16 v[224:239], v[140:143], a[152:155], v[224:239]
    ds_read_b64_tr_b16 v[156:157], v9 offset:14336
    ds_read_b64_tr_b16 v[158:159], v9 offset:14848
    v_cvt_pk_bf16_f32 v200, v200, v201
    v_cvt_pk_bf16_f32 v201, v202, v203
    v_cvt_pk_bf16_f32 v202, v204, v205
    v_cvt_pk_bf16_f32 v203, v206, v207
    v_mfma_f32_32x32x16_bf16 v[240:255], v[140:143], a[156:159], v[240:255]
    s_waitcnt lgkmcnt(4)
    buffer_load_dwordx4 v18, s[52:55], s92 offen offset:1024 lds
    s_xor_b32 s95, s87, 1024
    buffer_store_dwordx4 v[200:203], v1, s[48:51], s95 offen offset:2048 sc1
    v_mfma_f32_16x16x32_bf16 v[116:119], v[112:115], v[140:143], v[116:119]
    v_mfma_f32_32x32x16_bf16 v[224:239], v[144:147], a[160:163], v[224:239]
    s_waitcnt vmcnt(26)
    s_barrier
    ds_read_b64_tr_b16 v[128:129], v9 offset:16384
    ds_read_b64_tr_b16 v[130:131], v9 offset:16896
    v_mul_f32 v208, v25, v208
    v_mfma_f32_32x32x16_bf16 v[240:255], v[144:147], a[164:167], v[240:255]
    s_add_u32 m0, s101, 65536
    s_mul_i32 s91, s66, 3584
    buffer_load_dwordx4 v44, s[40:43], s91 offen offset:0  lds
    v_mul_f32 v209, v25, v209
    v_mfma_f32_16x16x32_bf16 v[116:119], v[112:115], v[144:147], v[116:119]
    v_mfma_f32_32x32x16_bf16 v[224:239], v[148:151], a[168:171], v[224:239]
    ds_read_b64_tr_b16 v[132:133], v9 offset:18432
    ds_read_b64_tr_b16 v[134:135], v9 offset:18944
    v_mul_f32 v210, v25, v210
    v_mul_f32 v211, v25, v211
    v_mul_f32 v212, v25, v212
    v_mfma_f32_32x32x16_bf16 v[240:255], v[148:151], a[172:175], v[240:255]
    s_waitcnt lgkmcnt(4)
    buffer_load_dwordx4 v45, s[40:43], s91 offen offset:1024  lds
    v_mul_f32 v213, v25, v213
    v_mul_f32 v214, v25, v214
    v_mfma_f32_16x16x32_bf16 v[116:119], v[112:115], v[148:151], v[116:119]
    v_mfma_f32_32x32x16_bf16 v[224:239], v[152:155], a[176:179], v[224:239]
    ds_read_b64_tr_b16 v[136:137], v9 offset:20480
    ds_read_b64_tr_b16 v[138:139], v9 offset:20992
    v_mul_f32 v215, v25, v215
    v_mul_f32 v216, v25, v216
    v_mul_f32 v217, v25, v217
    v_mfma_f32_32x32x16_bf16 v[240:255], v[152:155], a[180:183], v[240:255]
    buffer_load_dwordx4 v46, s[44:47], s91 offen offset:2048  lds
    v_mul_f32 v218, v25, v218
    v_mul_f32 v219, v25, v219
    v_mul_f32 v220, v25, v220
    v_mfma_f32_16x16x32_bf16 v[116:119], v[112:115], v[152:155], v[116:119]
    v_mfma_f32_32x32x16_bf16 v[224:239], v[156:159], a[184:187], v[224:239]
    ds_read_b64_tr_b16 v[140:141], v9 offset:22528
    ds_read_b64_tr_b16 v[142:143], v9 offset:23040
    v_mul_f32 v221, v25, v221
    v_mul_f32 v222, v25, v222
    v_mul_f32 v223, v25, v223
    v_mfma_f32_32x32x16_bf16 v[240:255], v[156:159], a[188:191], v[240:255]
    s_waitcnt lgkmcnt(4)
    buffer_load_dwordx4 v47, s[44:47], s91 offen offset:3072  lds
    v_cvt_pk_bf16_f32 v208, v208, v209
    v_cvt_pk_bf16_f32 v209, v210, v211
    v_mfma_f32_16x16x32_bf16 v[116:119], v[112:115], v[156:159], v[116:119]
    v_mfma_f32_32x32x16_bf16 v[224:239], v[128:131], a[192:195], v[224:239]
    ds_read_b64_tr_b16 v[144:145], v9 offset:24576
    ds_read_b64_tr_b16 v[146:147], v9 offset:25088
    v_cvt_pk_bf16_f32 v210, v212, v213
    v_cvt_pk_bf16_f32 v211, v214, v215
    s_xor_b32 s95, s87, 1024
    s_add_u32 s95, s95, 65536
    buffer_store_dwordx4 v[208:211], v1, s[48:51], s95 offen sc1
    v_mfma_f32_32x32x16_bf16 v[240:255], v[128:131], a[196:199], v[240:255]
    s_lshl2_add_u32 m0, s101, 94208
    s_lshl4_add_u32 s92, s61, s76
    s_add_u32 s92, s92, 32768
    buffer_load_dwordx4 v17, s[52:55], s92 offen offset:0 lds
    v_mfma_f32_16x16x32_bf16 v[116:119], v[112:115], v[128:131], v[116:119]
    v_mfma_f32_32x32x16_bf16 v[224:239], v[132:135], a[200:203], v[224:239]
    ds_read_b64_tr_b16 v[148:149], v9 offset:26624
    ds_read_b64_tr_b16 v[150:151], v9 offset:27136
    v_cvt_pk_bf16_f32 v216, v216, v217
    v_cvt_pk_bf16_f32 v217, v218, v219
    v_mfma_f32_32x32x16_bf16 v[240:255], v[132:135], a[204:207], v[240:255]
    s_waitcnt lgkmcnt(4)
    buffer_load_dwordx4 v18, s[52:55], s92 offen offset:1024 lds
    v_cvt_pk_bf16_f32 v218, v220, v221
    v_cvt_pk_bf16_f32 v219, v222, v223
    v_mfma_f32_16x16x32_bf16 v[116:119], v[112:115], v[132:135], v[116:119]
    v_mfma_f32_32x32x16_bf16 v[224:239], v[136:139], a[208:211], v[224:239]
    ds_read_b64_tr_b16 v[152:153], v9 offset:28672
    ds_read_b64_tr_b16 v[154:155], v9 offset:29184
    s_xor_b32 s95, s87, 1024
    s_add_u32 s95, s95, 65536
    buffer_store_dwordx4 v[216:219], v1, s[48:51], s95 offen offset:2048 sc1
    v_mfma_f32_32x32x16_bf16 v[240:255], v[136:139], a[212:215], v[240:255]
    s_lshl2_add_u32 m0, s101, 96256
    s_add_u32 s92, s92, 16384
    buffer_load_dwordx4 v17, s[52:55], s92 offen offset:0 lds
    v_mfma_f32_16x16x32_bf16 v[116:119], v[112:115], v[136:139], v[116:119]
    v_mfma_f32_32x32x16_bf16 v[224:239], v[140:143], a[216:219], v[224:239]
    ds_read_b64_tr_b16 v[156:157], v9 offset:30720
    ds_read_b64_tr_b16 v[158:159], v9 offset:31232
    v_mfma_f32_32x32x16_bf16 v[240:255], v[140:143], a[220:223], v[240:255]
    s_waitcnt lgkmcnt(4)
    buffer_load_dwordx4 v18, s[52:55], s92 offen offset:1024 lds
    v_mfma_f32_16x16x32_bf16 v[116:119], v[112:115], v[140:143], v[116:119]
    v_mfma_f32_32x32x16_bf16 v[224:239], v[144:147], a[224:227], v[224:239]
    s_waitcnt vmcnt(26)
    s_barrier
    ds_read_b64_tr_b16 v[128:129], v5 offset:32768
    ds_read_b64_tr_b16 v[130:131], v5 offset:33280
    s_waitcnt lgkmcnt(4)
    v_mfma_f32_16x16x32_bf16 v[116:119], v[112:115], v[152:155], v[116:119]
    v_mfma_f32_32x32x16_bf16 v[240:255], v[144:147], a[228:231], v[240:255]
    s_add_u32 m0, s101, 0
    s_mul_i32 s91, s67, 3584
    buffer_load_dwordx4 v44, s[40:43], s91 offen offset:0  lds
    v_mfma_f32_16x16x32_bf16 v[116:119], v[112:115], v[144:147], v[116:119]
    v_mfma_f32_32x32x16_bf16 v[224:239], v[148:151], a[232:235], v[224:239]
    ds_read_b64_tr_b16 v[132:133], v6 offset:32768
    ds_read_b64_tr_b16 v[134:135], v6 offset:33280
    s_waitcnt lgkmcnt(4)
    v_mfma_f32_16x16x32_bf16 v[116:119], v[112:115], v[156:159], v[116:119]
    v_mfma_f32_32x32x16_bf16 v[240:255], v[148:151], a[236:239], v[240:255]
    buffer_load_dwordx4 v45, s[40:43], s91 offen offset:1024  lds
    v_mfma_f32_16x16x32_bf16 v[116:119], v[112:115], v[148:151], v[116:119]
    v_mfma_f32_32x32x16_bf16 v[224:239], v[152:155], a[240:243], v[224:239]
    ds_read_b64_tr_b16 v[136:137], v5 offset:36864
    ds_read_b64_tr_b16 v[138:139], v5 offset:37376
    v_and_b32 v29, 256, v1
    v_cmp_eq_u32 vcc, 0, v29
    s_nop 3
    v_cndmask_b32 v96, v117, v116, vcc
    v_mfma_f32_32x32x16_bf16 v[240:255], v[152:155], a[244:247], v[240:255]
    buffer_load_dwordx4 v46, s[44:47], s91 offen offset:2048  lds
    v_cvt_pk_bf16_f32 v29, v96, v96
    v_lshlrev_b32 v29, 16, v29
    v_sub_f32 v29, v96, v29
    v_cvt_pk_bf16_f32 v96, v96, v29
    v_mfma_f32_32x32x16_bf16 v[224:239], v[156:159], a[248:251], v[224:239]
    ds_read_b64_tr_b16 v[140:141], v6 offset:36864
    ds_read_b64_tr_b16 v[142:143], v6 offset:37376
    v_mfma_f32_32x32x16_bf16 v[240:255], v[156:159], a[252:255], v[240:255]
    s_waitcnt lgkmcnt(4)
    buffer_load_dwordx4 v47, s[44:47], s91 offen offset:3072  lds
    v_mfma_f32_32x32x16_bf16 v[224:239], v[96:99], v[104:107], v[224:239]
L_p3:
    v_mfma_f32_32x32x16_bf16 v[160:175], v[128:131], a[0:3], 0
    ds_read_b64_tr_b16 v[144:145], v5 offset:40960
    ds_read_b64_tr_b16 v[146:147], v5 offset:41472
    v_mfma_f32_32x32x16_bf16 v[240:255], v[96:99], v[108:111], v[240:255]
    v_mfma_f32_32x32x16_bf16 v[176:191], v[128:131], a[4:7], 0
    s_lshl2_add_u32 m0, s101, 81920
    s_lshl4_add_u32 s92, s62, s76
    buffer_load_dwordx4 v17, s[52:55], s92 offen offset:0 lds
    v_mfma_f32_16x16x32_bf16 v[116:119], v[112:115], v[128:131], 0
    v_mfma_f32_32x32x16_bf16 v[192:207], v[132:135], a[0:3], 0
    ds_read_b64_tr_b16 v[148:149], v6 offset:40960
    ds_read_b64_tr_b16 v[150:151], v6 offset:41472
    v_mfma_f32_32x32x16_bf16 v[208:223], v[132:135], a[4:7], 0
    s_waitcnt lgkmcnt(4)
    buffer_load_dwordx4 v18, s[52:55], s92 offen offset:1024 lds
    v_mul_f32 v24, s84, v20
    v_mul_f32 v25, s84, v7
    v_mul_f32 v224, v24, v224
    v_mul_f32 v225, v24, v225
    v_mul_f32 v226, v24, v226
    v_mfma_f32_32x32x16_bf16 v[160:175], v[136:139], a[8:11], v[160:175]
    ds_read_b64_tr_b16 v[152:153], v5 offset:45056
    ds_read_b64_tr_b16 v[154:155], v5 offset:45568
    v_mul_f32 v227, v24, v227
    v_mul_f32 v228, v24, v228
    v_mul_f32 v229, v24, v229
    v_mul_f32 v230, v24, v230
    v_mul_f32 v231, v24, v231
    v_cvt_pk_bf16_f32 v224, v224, v225
    v_mfma_f32_32x32x16_bf16 v[176:191], v[136:139], a[12:15], v[176:191]
    s_lshl2_add_u32 m0, s101, 83968
    s_add_u32 s92, s92, 16384
    buffer_load_dwordx4 v17, s[52:55], s92 offen offset:0 lds
    v_cvt_pk_bf16_f32 v225, v226, v227
    v_cvt_pk_bf16_f32 v226, v228, v229
    v_mfma_f32_16x16x32_bf16 v[116:119], v[112:115], v[136:139], v[116:119]
    v_mfma_f32_32x32x16_bf16 v[192:207], v[140:143], a[8:11], v[192:207]
    ds_read_b64_tr_b16 v[156:157], v6 offset:45056
    ds_read_b64_tr_b16 v[158:159], v6 offset:45568
    v_cvt_pk_bf16_f32 v227, v230, v231
    buffer_store_dwordx4 v[224:227], v1, s[48:51], s89 offen offset:0 sc1
    v_mul_f32 v232, v24, v232
    v_mul_f32 v233, v24, v233
    v_mul_f32 v234, v24, v234
    v_mfma_f32_32x32x16_bf16 v[208:223], v[140:143], a[12:15], v[208:223]
    s_waitcnt lgkmcnt(4)
    buffer_load_dwordx4 v18, s[52:55], s92 offen offset:1024 lds
    v_mul_f32 v235, v24, v235
    v_mul_f32 v236, v24, v236
    v_mul_f32 v237, v24, v237
    v_mul_f32 v238, v24, v238
    v_mul_f32 v239, v24, v239
    v_mfma_f32_32x32x16_bf16 v[160:175], v[144:147], a[16:19], v[160:175]
    s_waitcnt vmcnt(23)
    s_barrier
    ds_read_b64_tr_b16 v[128:129], v5 offset:49152
    ds_read_b64_tr_b16 v[130:131], v5 offset:49664
    v_cvt_pk_bf16_f32 v232, v232, v233
    v_cvt_pk_bf16_f32 v233, v234, v235
    v_cvt_pk_bf16_f32 v234, v236, v237
    v_cvt_pk_bf16_f32 v235, v238, v239
    v_mfma_f32_32x32x16_bf16 v[176:191], v[144:147], a[20:23], v[176:191]
    s_add_u32 m0, s101, 16384
    s_mul_i32 s91, s68, 3584
    buffer_load_dwordx4 v44, s[40:43], s91 offen offset:0  lds
    buffer_store_dwordx4 v[232:235], v1, s[48:51], s89 offen offset:1024 sc1
    v_mul_f32 v240, v25, v240
    v_mfma_f32_16x16x32_bf16 v[116:119], v[112:115], v[144:147], v[116:119]
    v_mfma_f32_32x32x16_bf16 v[192:207], v[148:151], a[16:19], v[192:207]
    ds_read_b64_tr_b16 v[132:133], v6 offset:49152
    ds_read_b64_tr_b16 v[134:135], v6 offset:49664
    v_mul_f32 v241, v25, v241
    v_mul_f32 v242, v25, v242
    v_mul_f32 v243, v25, v243
    v_mul_f32 v244, v25, v244
    v_mul_f32 v245, v25, v245
    v_mfma_f32_32x32x16_bf16 v[208:223], v[148:151], a[20:23], v[208:223]
    s_waitcnt lgkmcnt(4)
    buffer_load_dwordx4 v45, s[40:43], s91 offen offset:1024  lds
    v_mul_f32 v246, v25, v246
    v_mul_f32 v247, v25, v247
    v_cvt_pk_bf16_f32 v240, v240, v241
    v_cvt_pk_bf16_f32 v241, v242, v243
    v_cvt_pk_bf16_f32 v242, v244, v245
    v_mfma_f32_32x32x16_bf16 v[160:175], v[152:155], a[24:27], v[160:175]
    ds_read_b64_tr_b16 v[136:137], v5 offset:53248
    ds_read_b64_tr_b16 v[138:139], v5 offset:53760
    v_cvt_pk_bf16_f32 v243, v246, v247
    buffer_store_dwordx4 v[240:243], v1, s[48:51], s90 offen offset:0 sc1
    v_mul_f32 v248, v25, v248
    v_mul_f32 v249, v25, v249
    v_mul_f32 v250, v25, v250
    v_mul_f32 v251, v25, v251
    v_mfma_f32_32x32x16_bf16 v[176:191], v[152:155], a[28:31], v[176:191]
    buffer_load_dwordx4 v46, s[44:47], s91 offen offset:2048  lds
    v_mul_f32 v252, v25, v252
    v_mul_f32 v253, v25, v253
    v_mul_f32 v254, v25, v254
    v_mul_f32 v255, v25, v255
    v_mfma_f32_16x16x32_bf16 v[116:119], v[112:115], v[152:155], v[116:119]
    v_mfma_f32_32x32x16_bf16 v[192:207], v[156:159], a[24:27], v[192:207]
    ds_read_b64_tr_b16 v[140:141], v6 offset:53248
    ds_read_b64_tr_b16 v[142:143], v6 offset:53760
    v_cvt_pk_bf16_f32 v248, v248, v249
    v_cvt_pk_bf16_f32 v249, v250, v251
    v_cvt_pk_bf16_f32 v250, v252, v253
    v_cvt_pk_bf16_f32 v251, v254, v255
    buffer_store_dwordx4 v[248:251], v1, s[48:51], s90 offen offset:1024 sc1
    v_mfma_f32_32x32x16_bf16 v[208:223], v[156:159], a[28:31], v[208:223]
    s_waitcnt lgkmcnt(4)
    buffer_load_dwordx4 v47, s[44:47], s91 offen offset:3072  lds
    v_mfma_f32_32x32x16_bf16 v[160:175], v[128:131], a[32:35], v[160:175]
    ds_read_b64_tr_b16 v[144:145], v5 offset:57344
    ds_read_b64_tr_b16 v[146:147], v5 offset:57856
    v_lshrrev_b32 v24, 4, v1
    v_lshrrev_b32 v25, 5, v24
    v_bfe_u32 v26, v24, 4, 1
    v_mfma_f32_32x32x16_bf16 v[176:191], v[128:131], a[36:39], v[176:191]
    v_bfe_u32 v27, v24, 2, 2
    s_mul_i32 s98, s3, 4160
    v_mfma_f32_16x16x32_bf16 v[116:119], v[112:115], v[128:131], v[116:119]
    v_mfma_f32_32x32x16_bf16 v[192:207], v[132:135], a[32:35], v[192:207]
    ds_read_b64_tr_b16 v[148:149], v6 offset:57344
    ds_read_b64_tr_b16 v[150:151], v6 offset:57856
    s_add_u32 s98, s98, 65536
    v_add_u32 v236, s98, v1
    v_lshl_add_u32 v29, v25, 2, v27
    v_mfma_f32_32x32x16_bf16 v[208:223], v[132:135], a[36:39], v[208:223]
    s_waitcnt lgkmcnt(4)
    v_lshlrev_b32 v29, 4, v29
    v_and_b32 v239, 1, v24
    v_lshl_add_u32 v29, v239, 9, v29
    v_mfma_f32_32x32x16_bf16 v[160:175], v[136:139], a[40:43], v[160:175]
    ds_read_b64_tr_b16 v[152:153], v5 offset:61440
    ds_read_b64_tr_b16 v[154:155], v5 offset:61952
    v_bfe_u32 v239, v24, 1, 1
    v_lshl_add_u32 v29, v239, 3, v29
    v_mfma_f32_32x32x16_bf16 v[176:191], v[136:139], a[44:47], v[176:191]
    v_cmp_eq_u32 vcc, 0, v26
    v_add_u32 v29, 2048, v29
    v_mov_b32 v239, 4096
    v_mfma_f32_16x16x32_bf16 v[116:119], v[112:115], v[136:139], v[116:119]
    v_mfma_f32_32x32x16_bf16 v[192:207], v[140:143], a[40:43], v[192:207]
    ds_read_b64_tr_b16 v[156:157], v6 offset:61440
    ds_read_b64_tr_b16 v[158:159], v6 offset:61952
    v_cndmask_b32 v232, v239, v29, vcc
    v_add_u32 v232, s98, v232
    v_sub_u32 v239, 1, v26
    v_mfma_f32_32x32x16_bf16 v[208:223], v[140:143], a[44:47], v[208:223]
    s_waitcnt lgkmcnt(4)
    v_lshlrev_b32 v237, 10, v239
    v_lshl_add_u32 v233, v239, 7, v232
    v_add_u32 v5, 65536, v5
    v_add_u32 v6, 65536, v6
    v_mfma_f32_32x32x16_bf16 v[160:175], v[144:147], a[48:51], v[160:175]
    s_waitcnt vmcnt(21)
    s_barrier
    ds_read_b64_tr_b16 v[128:129], v5 offset:0
    ds_read_b64_tr_b16 v[130:131], v5 offset:512
    s_waitcnt vmcnt(13)
    v_mov_b32 v23, s83
    buffer_store_dword v23, v19, s[48:51], 0 offen offset:20 sc1
    v_mfma_f32_32x32x16_bf16 v[176:191], v[144:147], a[52:55], v[176:191]
    s_add_u32 m0, s101, 32768
    ds_read_b64_tr_b16 a[32:33], v126 offset:0
    ds_read_b64_tr_b16 a[34:35], v126 offset:1024
    s_mul_i32 s91, s69, 3584
    buffer_load_dwordx4 v44, s[40:43], s91 offen offset:0  lds
    v_mfma_f32_16x16x32_bf16 v[116:119], v[112:115], v[144:147], v[116:119]
    v_mfma_f32_32x32x16_bf16 v[192:207], v[148:151], a[48:51], v[192:207]
    ds_read_b64_tr_b16 v[132:133], v6 offset:0
    ds_read_b64_tr_b16 v[134:135], v6 offset:512
    v_lshl_add_u32 v234, v239, 8, v232
    v_lshl_add_u32 v235, v239, 8, v233
    v_mfma_f32_32x32x16_bf16 v[208:223], v[148:151], a[52:55], v[208:223]
    s_waitcnt lgkmcnt(6)
    ds_read_b64_tr_b16 a[36:37], v127 offset:0
    ds_read_b64_tr_b16 a[38:39], v127 offset:1024
    buffer_load_dwordx4 v45, s[40:43], s91 offen offset:1024  lds
    v_min_u32 v29, 11, v24
    v_mfma_f32_32x32x16_bf16 v[160:175], v[152:155], a[56:59], v[160:175]
    ds_read_b64_tr_b16 v[136:137], v5 offset:4096
    ds_read_b64_tr_b16 v[138:139], v5 offset:4608
    s_lshl_b32 s98, s79, 2
    s_sub_u32 s98, 8, s98
    v_cmp_le_i32 vcc, s98, v29
    v_mfma_f32_32x32x16_bf16 v[176:191], v[152:155], a[60:63], v[176:191]
    ds_read_b64_tr_b16 a[40:41], v126 offset:2048
    ds_read_b64_tr_b16 a[42:43], v126 offset:3072
    buffer_load_dwordx4 v46, s[44:47], s91 offen offset:2048  lds
    v_mul_u32_u24 v29, 4160, v29
    v_mfma_f32_16x16x32_bf16 v[116:119], v[112:115], v[152:155], v[116:119]
    v_mfma_f32_32x32x16_bf16 v[192:207], v[156:159], a[56:59], v[192:207]
    ds_read_b64_tr_b16 v[140:141], v6 offset:4096
    ds_read_b64_tr_b16 v[142:143], v6 offset:4608
    v_mov_b32 v239, 0x3f803f80
    v_add_u32 v248, 69632, v29
    v_mfma_f32_32x32x16_bf16 v[208:223], v[156:159], a[60:63], v[208:223]
    s_waitcnt lgkmcnt(8)
    ds_read_b64_tr_b16 a[44:45], v127 offset:2048
    ds_read_b64_tr_b16 a[46:47], v127 offset:3072
    buffer_load_dwordx4 v47, s[44:47], s91 offen offset:3072  lds
    v_cndmask_b32 v246, 0, v239, vcc
    v_mfma_f32_32x32x16_bf16 v[160:175], v[128:131], a[64:67], v[160:175]
    ds_read_b64_tr_b16 v[144:145], v5 offset:8192
    ds_read_b64_tr_b16 v[146:147], v5 offset:8704
    v_cndmask_b32 v247, 0, v239, vcc
    s_mov_b32 s63, s18
    s_mov_b32 s99, s19
    v_mfma_f32_32x32x16_bf16 v[176:191], v[128:131], a[68:71], v[176:191]
    ds_read_b64_tr_b16 a[48:49], v2 offset:4096
    ds_read_b64_tr_b16 a[50:51], v2 offset:5120
    s_mov_b32 s4, 0xffffffff
    v_mfma_f32_16x16x32_bf16 v[116:119], v[112:115], v[128:131], v[116:119]
    v_mfma_f32_32x32x16_bf16 v[192:207], v[132:135], a[64:67], v[192:207]
    s_add_u32 m0, s101, 147456
    ds_read_b64_tr_b16 v[148:149], v6 offset:8192
    ds_read_b64_tr_b16 v[150:151], v6 offset:8704
    s_waitcnt lgkmcnt(6)
    s_lshl4_add_u32 s92, s62, s76
    s_add_u32 s92, s92, 32768
    buffer_load_dwordx4 v17, s[52:55], s92 offen offset:0 lds
    s_waitcnt vmcnt(7)
    v_mov_b32 v23, s83
    buffer_store_dword v23, v19, s[48:51], 0 offen offset:0 sc1
    v_mfma_f32_32x32x16_bf16 v[208:223], v[132:135], a[68:71], v[208:223]
    ds_read_b64_tr_b16 a[52:53], v28 offset:4096
    ds_read_b64_tr_b16 a[54:55], v28 offset:5120
    s_mov_b32 s5, 0xfffffff0
    s_mov_b32 s6, 0xfffffffe
    v_mfma_f32_32x32x16_bf16 v[160:175], v[136:139], a[72:75], v[160:175]
    ds_read_b64_tr_b16 v[152:153], v5 offset:12288
    ds_read_b64_tr_b16 v[154:155], v5 offset:12800
    buffer_load_dwordx4 v18, s[52:55], s92 offen offset:1024 lds
    s_mov_b32 s7, 0xffffffe0
    v_mfma_f32_32x32x16_bf16 v[176:191], v[136:139], a[76:79], v[176:191]
    ds_read_b64_tr_b16 a[56:57], v2 offset:6144
    ds_read_b64_tr_b16 a[58:59], v2 offset:7168
    s_mov_b32 s8, 0xfffffffc
    s_mov_b32 s9, 0xffffffc0
    v_mfma_f32_16x16x32_bf16 v[116:119], v[112:115], v[136:139], v[116:119]
    v_mfma_f32_32x32x16_bf16 v[192:207], v[140:143], a[72:75], v[192:207]
    s_add_u32 m0, s101, 149504
    ds_read_b64_tr_b16 v[156:157], v6 offset:12288
    ds_read_b64_tr_b16 v[158:159], v6 offset:12800
    s_add_u32 s92, s92, 16384
    buffer_load_dwordx4 v17, s[52:55], s92 offen offset:0 lds
    v_mfma_f32_32x32x16_bf16 v[208:223], v[140:143], a[76:79], v[208:223]
    s_waitcnt lgkmcnt(8)
    ds_read_b64_tr_b16 a[60:61], v28 offset:6144
    ds_read_b64_tr_b16 a[62:63], v28 offset:7168
    s_mov_b32 s10, 0xfffffff8
    v_subrev_u32 v5, 65536, v5
    v_subrev_u32 v6, 65536, v6
    v_mfma_f32_32x32x16_bf16 v[160:175], v[144:147], a[80:83], v[160:175]
    s_barrier
    ds_read_b64_tr_b16 v[128:129], v5 offset:0
    ds_read_b64_tr_b16 v[130:131], v5 offset:512
    s_mov_b32 s11, 0xffffff80
    v_mfma_f32_32x32x16_bf16 v[176:191], v[144:147], a[84:87], v[176:191]
    ds_read_b64_tr_b16 a[64:65], v2 offset:8192
    ds_read_b64_tr_b16 a[66:67], v2 offset:9216
    buffer_load_dwordx4 v18, s[52:55], s92 offen offset:1024 lds
    v_mfma_f32_16x16x32_bf16 v[116:119], v[112:115], v[144:147], v[116:119]
    v_mfma_f32_32x32x16_bf16 v[192:207], v[148:151], a[80:83], v[192:207]
    ds_read_b64_tr_b16 v[132:133], v6 offset:0
    ds_read_b64_tr_b16 v[134:135], v6 offset:512
    s_mov_b32 s12, 0xffffff00
    s_mov_b32 s13, 0xfffff000
    s_mov_b32 s14, 0xfffffe00
    v_mfma_f32_32x32x16_bf16 v[208:223], v[148:151], a[84:87], v[208:223]
    s_add_u32 m0, s101, 49152
    s_waitcnt lgkmcnt(8)
    ds_read_b64_tr_b16 a[68:69], v28 offset:8192
    ds_read_b64_tr_b16 a[70:71], v28 offset:9216
    s_mul_i32 s91, s70, 3584
    buffer_load_dwordx4 v44, s[40:43], s91 offen offset:0  lds
    v_mfma_f32_32x32x16_bf16 v[160:175], v[152:155], a[88:91], v[160:175]
    ds_read_b64_tr_b16 v[136:137], v5 offset:4096
    ds_read_b64_tr_b16 v[138:139], v5 offset:4608
    s_mov_b32 s15, 0xffffe000
    s_mov_b32 s16, 0xfffffc00
    v_mfma_f32_32x32x16_bf16 v[176:191], v[152:155], a[92:95], v[176:191]
    ds_read_b64_tr_b16 a[72:73], v2 offset:10240
    ds_read_b64_tr_b16 a[74:75], v2 offset:11264
    buffer_load_dwordx4 v45, s[40:43], s91 offen offset:1024  lds
    s_mov_b32 s17, 0xffffc000
    v_mfma_f32_16x16x32_bf16 v[116:119], v[112:115], v[152:155], v[116:119]
    v_mfma_f32_32x32x16_bf16 v[192:207], v[156:159], a[88:91], v[192:207]
    ds_read_b64_tr_b16 v[140:141], v6 offset:4096
    ds_read_b64_tr_b16 v[142:143], v6 offset:4608
    s_mov_b32 s18, 0xfffff800
    s_mov_b32 s19, 0xffff8000
    s_mov_b32 s20, 0xffff0000
    v_mfma_f32_32x32x16_bf16 v[208:223], v[156:159], a[92:95], v[208:223]
    s_waitcnt lgkmcnt(8)
    ds_read_b64_tr_b16 a[76:77], v28 offset:10240
    ds_read_b64_tr_b16 a[78:79], v28 offset:11264
    buffer_load_dwordx4 v46, s[44:47], s91 offen offset:2048  lds
    s_mov_b32 s21, 0xfff00000
    v_mfma_f32_32x32x16_bf16 v[160:175], v[128:131], a[96:99], v[160:175]
    ds_read_b64_tr_b16 v[144:145], v5 offset:8192
    ds_read_b64_tr_b16 v[146:147], v5 offset:8704
    s_mov_b32 s22, 0xfffe0000
    s_mov_b32 s23, 0xffe00000
    v_mfma_f32_32x32x16_bf16 v[176:191], v[128:131], a[100:103], v[176:191]
    ds_read_b64_tr_b16 a[80:81], v2 offset:12288
    ds_read_b64_tr_b16 a[82:83], v2 offset:13312
    buffer_load_dwordx4 v47, s[44:47], s91 offen offset:3072  lds
    v_mfma_f32_16x16x32_bf16 v[116:119], v[112:115], v[128:131], v[116:119]
    v_mfma_f32_32x32x16_bf16 v[192:207], v[132:135], a[96:99], v[192:207]
    ds_read_b64_tr_b16 v[148:149], v6 offset:8192
    ds_read_b64_tr_b16 v[150:151], v6 offset:8704
    s_add_u32 s92, s82, 0
    s_and_b32 s95, s92, 1
    s_and_b32 s92, s92, 6
    s_lshl1_add_u32 s92, s92, s95
    v_mfma_f32_32x32x16_bf16 v[208:223], v[132:135], a[100:103], v[208:223]
    s_lshl2_add_u32 m0, s101, 86016
    s_waitcnt lgkmcnt(8)
    ds_read_b64_tr_b16 a[84:85], v28 offset:12288
    ds_read_b64_tr_b16 a[86:87], v28 offset:13312
    s_lshl_b32 s92, s92, 11
    s_lshl4_add_u32 s92, s92, s76
    buffer_load_dwordx4 v17, s[52:55], s92 offen offset:0 lds
    v_mfma_f32_32x32x16_bf16 v[160:175], v[136:139], a[104:107], v[160:175]
    ds_read_b64_tr_b16 v[152:153], v5 offset:12288
    ds_read_b64_tr_b16 v[154:155], v5 offset:12800
    s_mov_b32 s28, 0xfffc0000
    s_mov_b32 s29, 0xffc00000
    s_mov_b32 s30, 0xfff80000
    v_mfma_f32_32x32x16_bf16 v[176:191], v[136:139], a[108:111], v[176:191]
    ds_read_b64_tr_b16 a[88:89], v2 offset:14336
    ds_read_b64_tr_b16 a[90:91], v2 offset:15360
    buffer_load_dwordx4 v18, s[52:55], s92 offen offset:1024 lds
    s_mov_b32 s31, 0xff800000
    v_mfma_f32_16x16x32_bf16 v[116:119], v[112:115], v[136:139], v[116:119]
    v_mfma_f32_32x32x16_bf16 v[192:207], v[140:143], a[104:107], v[192:207]
    ds_read_b64_tr_b16 v[156:157], v6 offset:12288
    ds_read_b64_tr_b16 v[158:159], v6 offset:12800
    s_mov_b32 s32, 0xff000000
    s_mov_b32 s33, 0xf0000000
    v_mfma_f32_32x32x16_bf16 v[208:223], v[140:143], a[108:111], v[208:223]
    s_lshl2_add_u32 m0, s101, 88064
    s_waitcnt lgkmcnt(8)
    ds_read_b64_tr_b16 a[92:93], v28 offset:14336
    ds_read_b64_tr_b16 a[94:95], v28 offset:15360
    s_add_u32 s92, s92, 16384
    buffer_load_dwordx4 v17, s[52:55], s92 offen offset:0 lds
    v_mfma_f32_32x32x16_bf16 v[160:175], v[144:147], a[112:115], v[160:175]
    s_waitcnt vmcnt(17)
    s_barrier
    ds_read_b64_tr_b16 v[128:129], v5 offset:16384
    ds_read_b64_tr_b16 v[130:131], v5 offset:16896
    s_mov_b32 s34, 0xfe000000
    s_mov_b32 s35, 0xe0000000
    v_mfma_f32_32x32x16_bf16 v[176:191], v[144:147], a[116:119], v[176:191]
    ds_read_b64_tr_b16 a[96:97], v2 offset:0
    ds_read_b64_tr_b16 a[98:99], v2 offset:1024
    buffer_load_dwordx4 v18, s[52:55], s92 offen offset:1024 lds
    v_mfma_f32_16x16x32_bf16 v[116:119], v[112:115], v[144:147], v[116:119]
    v_mfma_f32_32x32x16_bf16 v[192:207], v[148:151], a[112:115], v[192:207]
    ds_read_b64_tr_b16 v[132:133], v6 offset:16384
    ds_read_b64_tr_b16 v[134:135], v6 offset:16896
    s_add_u32 s92, s82, 1
    s_and_b32 s95, s92, 1
    s_and_b32 s92, s92, 6
    s_lshl1_add_u32 s92, s92, s95
    v_mfma_f32_32x32x16_bf16 v[208:223], v[148:151], a[116:119], v[208:223]
    s_lshl2_add_u32 m0, s101, 90112
    s_waitcnt lgkmcnt(8)
    ds_read_b64_tr_b16 a[100:101], v28 offset:0
    ds_read_b64_tr_b16 a[102:103], v28 offset:1024
    s_lshl_b32 s92, s92, 11
    s_lshl4_add_u32 s92, s92, s76
    buffer_load_dwordx4 v17, s[52:55], s92 offen offset:0 lds
    v_mfma_f32_32x32x16_bf16 v[160:175], v[152:155], a[120:123], v[160:175]
    ds_read_b64_tr_b16 v[136:137], v5 offset:20480
    ds_read_b64_tr_b16 v[138:139], v5 offset:20992
    s_mov_b32 s36, 0xfc000000
    s_mov_b32 s37, 0xc0000000
    v_mfma_f32_32x32x16_bf16 v[176:191], v[152:155], a[124:127], v[176:191]
    ds_read_b64_tr_b16 a[104:105], v2 offset:2048
    ds_read_b64_tr_b16 a[106:107], v2 offset:3072
    buffer_load_dwordx4 v18, s[52:55], s92 offen offset:1024 lds
    s_mov_b32 s38, 0xf8000000
    v_mfma_f32_16x16x32_bf16 v[116:119], v[112:115], v[152:155], v[116:119]
    v_mfma_f32_32x32x16_bf16 v[192:207], v[156:159], a[120:123], v[192:207]
    ds_read_b64_tr_b16 v[140:141], v6 offset:20480
    ds_read_b64_tr_b16 v[142:143], v6 offset:20992
    s_mov_b32 s39, 0x80000000
    v_mov_b32 v239, 0xffff
    v_mfma_f32_32x32x16_bf16 v[208:223], v[156:159], a[124:127], v[208:223]
    s_lshl2_add_u32 m0, s101, 92160
    s_waitcnt lgkmcnt(8)
    ds_read_b64_tr_b16 a[108:109], v28 offset:2048
    ds_read_b64_tr_b16 a[110:111], v28 offset:3072
    s_add_u32 s92, s92, 16384
    buffer_load_dwordx4 v17, s[52:55], s92 offen offset:0 lds
    v_mfma_f32_32x32x16_bf16 v[160:175], v[128:131], a[128:131], v[160:175]
    ds_read_b64_tr_b16 v[144:145], v5 offset:24576
    ds_read_b64_tr_b16 v[146:147], v5 offset:25088
    v_mov_b32 v27, s85
    v_cndmask_b32 v224, 0, v239, s[4:5]
    v_cndmask_b32 v29, 0, v27, s[6:7]
    v_mfma_f32_32x32x16_bf16 v[176:191], v[128:131], a[132:135], v[176:191]
    buffer_load_dwordx4 v18, s[52:55], s92 offen offset:1024 lds
    v_or_b32 v224, v224, v29
    v_cndmask_b32 v225, 0, v239, s[8:9]
    v_mfma_f32_16x16x32_bf16 v[116:119], v[112:115], v[128:131], v[116:119]
    v_mfma_f32_32x32x16_bf16 v[192:207], v[132:135], a[128:131], v[192:207]
    ds_read_b64_tr_b16 v[148:149], v6 offset:24576
    ds_read_b64_tr_b16 v[150:151], v6 offset:25088
    v_cndmask_b32 v29, 0, v27, s[10:11]
    v_or_b32 v225, v225, v29
    v_mfma_f32_32x32x16_bf16 v[208:223], v[132:135], a[132:135], v[208:223]
    s_waitcnt lgkmcnt(6)
    v_cndmask_b32 v226, 0, v239, s[12:13]
    v_cndmask_b32 v29, 0, v27, s[14:15]
    v_or_b32 v226, v226, v29
    v_cndmask_b32 v227, 0, v239, s[16:17]
    v_mfma_f32_32x32x16_bf16 v[160:175], v[136:139], a[136:139], v[160:175]
    ds_read_b64_tr_b16 v[152:153], v5 offset:28672
    ds_read_b64_tr_b16 v[154:155], v5 offset:29184
    v_cndmask_b32 v29, 0, v27, s[18:19]
    v_or_b32 v227, v227, v29
    v_mfma_f32_32x32x16_bf16 v[176:191], v[136:139], a[140:143], v[176:191]
    s_waitcnt vmcnt(12)
    ds_read_b64_tr_b16 a[112:113], v126 offset:0
    ds_read_b64_tr_b16 a[114:115], v126 offset:1024
    v_cndmask_b32 v228, 0, v239, s[20:21]
    v_mfma_f32_16x16x32_bf16 v[116:119], v[112:115], v[136:139], v[116:119]
    v_mfma_f32_32x32x16_bf16 v[192:207], v[140:143], a[136:139], v[192:207]
    ds_read_b64_tr_b16 v[156:157], v6 offset:28672
    ds_read_b64_tr_b16 v[158:159], v6 offset:29184
    v_cndmask_b32 v29, 0, v27, s[22:23]
    v_or_b32 v228, v228, v29
    v_mfma_f32_32x32x16_bf16 v[208:223], v[140:143], a[140:143], v[208:223]
    s_waitcnt lgkmcnt(6)
    ds_read_b64_tr_b16 a[116:117], v127 offset:0
    ds_read_b64_tr_b16 a[118:119], v127 offset:1024
    v_cndmask_b32 v229, 0, v239, s[28:29]
    v_cndmask_b32 v29, 0, v27, s[30:31]
    v_mfma_f32_32x32x16_bf16 v[160:175], v[144:147], a[144:147], v[160:175]
    s_barrier
    ds_read_b64_tr_b16 v[128:129], v5 offset:32768
    ds_read_b64_tr_b16 v[130:131], v5 offset:33280
    v_or_b32 v229, v229, v29
    v_cndmask_b32 v230, 0, v239, s[32:33]
    v_mfma_f32_32x32x16_bf16 v[176:191], v[144:147], a[148:151], v[176:191]
    s_add_u32 m0, s101, 0
    ds_read_b64_tr_b16 a[120:121], v126 offset:2048
    ds_read_b64_tr_b16 a[122:123], v126 offset:3072
    s_mul_i32 s91, s71, 3584
    buffer_load_dwordx4 v44, s[40:43], s91 offen offset:0  lds
    v_mfma_f32_16x16x32_bf16 v[116:119], v[112:115], v[144:147], v[116:119]
    v_mfma_f32_32x32x16_bf16 v[192:207], v[148:151], a[144:147], v[192:207]
    ds_read_b64_tr_b16 v[132:133], v6 offset:32768
    ds_read_b64_tr_b16 v[134:135], v6 offset:33280
    buffer_load_dwordx4 v45, s[40:43], s91 offen offset:1024  lds
    v_cndmask_b32 v29, 0, v27, s[34:35]
    v_mfma_f32_32x32x16_bf16 v[208:223], v[148:151], a[148:151], v[208:223]
    s_waitcnt lgkmcnt(8)
    ds_read_b64_tr_b16 a[124:125], v127 offset:2048
    ds_read_b64_tr_b16 a[126:127], v127 offset:3072
    buffer_load_dwordx4 v46, s[44:47], s91 offen offset:2048  lds
    v_or_b32 v230, v230, v29
    v_cndmask_b32 v231, 0, v239, s[36:37]
    v_mfma_f32_32x32x16_bf16 v[160:175], v[152:155], a[152:155], v[160:175]
    ds_read_b64_tr_b16 v[136:137], v5 offset:36864
    ds_read_b64_tr_b16 v[138:139], v5 offset:37376
    buffer_load_dwordx4 v47, s[44:47], s91 offen offset:3072  lds
    v_cndmask_b32 v29, 0, v27, s[38:39]
    v_or_b32 v231, v231, v29
    v_mfma_f32_32x32x16_bf16 v[176:191], v[152:155], a[156:159], v[176:191]
    s_lshr_b32 s98, s3, 1
    s_mul_i32 s98, s98, 147456
    s_mov_b32 s64, s63
    v_mfma_f32_16x16x32_bf16 v[116:119], v[112:115], v[152:155], v[116:119]
    v_mfma_f32_32x32x16_bf16 v[192:207], v[156:159], a[152:155], v[192:207]
    ds_read_b64_tr_b16 v[140:141], v6 offset:36864
    ds_read_b64_tr_b16 v[142:143], v6 offset:37376
    v_add_u32 v3, s98, v1
    s_sub_u32 s98, 147456, s98
    v_add_u32 v4, s98, v1
    v_mfma_f32_32x32x16_bf16 v[208:223], v[156:159], a[156:159], v[208:223]
    s_waitcnt lgkmcnt(6)
    s_lshl_b32 s87, s3, 14
    s_sub_u32 s98, s87, s77
    v_add_u32 v9, s98, v15
    s_mov_b32 s65, s99
    v_mfma_f32_32x32x16_bf16 v[160:175], v[128:131], a[160:163], v[160:175]
    ds_read_b64_tr_b16 v[144:145], v5 offset:40960
    ds_read_b64_tr_b16 v[146:147], v5 offset:41472
    buffer_load_dword v30, v22, s[48:51], 0 offen offset:20 sc1
    v_add_u32 v10, s98, v16
    s_mul_i32 s72, s81, 294912
    s_mov_b32 s66, 2097152
    v_mfma_f32_32x32x16_bf16 v[176:191], v[128:131], a[164:167], v[176:191]
    s_lshl_b32 s98, s3, 13
    s_add_u32 s72, s72, s98
    s_mov_b32 s67, 0x20000
    v_mfma_f32_16x16x32_bf16 v[116:119], v[112:115], v[128:131], v[116:119]
    v_mfma_f32_32x32x16_bf16 v[192:207], v[132:135], a[160:163], v[192:207]
    ds_read_b64_tr_b16 v[148:149], v6 offset:40960
    ds_read_b64_tr_b16 v[150:151], v6 offset:41472
    s_add_u32 s72, s72, 8503296
    s_and_b32 s98, s81, 0
    s_lshl_b32 s98, s98, 12
    v_mfma_f32_32x32x16_bf16 v[208:223], v[132:135], a[164:167], v[208:223]
    s_waitcnt lgkmcnt(4)
    s_sub_u32 s73, s72, s98
    s_add_u32 s73, s73, 4096
    s_add_u32 s72, s72, s98
    v_mfma_f32_32x32x16_bf16 v[160:175], v[136:139], a[168:171], v[160:175]
    ds_read_b64_tr_b16 v[152:153], v5 offset:45056
    ds_read_b64_tr_b16 v[154:155], v5 offset:45568
    s_add_u32 s74, s72, 1024
    s_add_u32 s75, s73, 1024
    v_bfe_u32 v29, v24, 1, 2
    v_mfma_f32_32x32x16_bf16 v[176:191], v[136:139], a[172:175], v[176:191]
    s_waitcnt vmcnt(9)
    ds_read_b64_tr_b16 a[128:129], v2 offset:4096
    ds_read_b64_tr_b16 a[130:131], v2 offset:5120
    v_mfma_f32_16x16x32_bf16 v[116:119], v[112:115], v[136:139], v[116:119]
    v_mfma_f32_32x32x16_bf16 v[192:207], v[140:143], a[168:171], v[192:207]
    ds_read_b64_tr_b16 v[156:157], v6 offset:45056
    ds_read_b64_tr_b16 v[158:159], v6 offset:45568
    s_lshr_b32 s98, s81, 1
    s_lshl2_add_u32 s98, s98, s3
    s_lshl_b32 s98, s98, 2
    v_mfma_f32_32x32x16_bf16 v[208:223], v[140:143], a[172:175], v[208:223]
    s_waitcnt lgkmcnt(6)
    ds_read_b64_tr_b16 a[132:133], v28 offset:4096
    ds_read_b64_tr_b16 a[134:135], v28 offset:5120
    v_add_u32 v29, s98, v29
    v_and_b32 v239, 1, v24
    s_add_u32 s40, s82, 0
    s_and_b32 s96, s40, 1
    s_and_b32 s40, s40, 6
    s_lshl1_add_u32 s40, s40, s96
    s_lshl_b32 s40, s40, 11
    v_mfma_f32_32x32x16_bf16 v[160:175], v[144:147], a[176:179], v[160:175]
    s_barrier
    ds_read_b64_tr_b16 v[128:129], v5 offset:49152
    ds_read_b64_tr_b16 v[130:131], v5 offset:49664
    s_and_b32 s98, s81, 1
    v_mfma_f32_32x32x16_bf16 v[176:191], v[144:147], a[180:183], v[176:191]
    ds_read_b64_tr_b16 a[136:137], v2 offset:6144
    ds_read_b64_tr_b16 a[138:139], v2 offset:7168
    s_lshl_b32 s98, s98, 1
    v_mfma_f32_16x16x32_bf16 v[116:119], v[112:115], v[144:147], v[116:119]
    v_mfma_f32_32x32x16_bf16 v[192:207], v[148:151], a[176:179], v[192:207]
    ds_read_b64_tr_b16 v[132:133], v6 offset:49152
    ds_read_b64_tr_b16 v[134:135], v6 offset:49664
    v_add_u32 v239, s98, v239
    v_lshl_add_u32 v29, v29, 2, v239
    v_lshlrev_b32 v238, 7, v29
    v_mfma_f32_32x32x16_bf16 v[208:223], v[148:151], a[180:183], v[208:223]
    s_waitcnt lgkmcnt(8)
    ds_read_b64_tr_b16 a[140:141], v28 offset:6144
    ds_read_b64_tr_b16 a[142:143], v28 offset:7168
    s_lshr_b32 s98, s3, 1
    s_lshl1_add_u32 s98, s81, s98
    v_mfma_f32_32x32x16_bf16 v[160:175], v[152:155], a[184:187], v[160:175]
    ds_read_b64_tr_b16 v[136:137], v5 offset:53248
    ds_read_b64_tr_b16 v[138:139], v5 offset:53760
    s_lshl_b32 s90, s98, 15
    s_and_b32 s98, s3, 1
    s_lshl_b32 s98, s98, 6
    v_mfma_f32_32x32x16_bf16 v[176:191], v[152:155], a[188:191], v[176:191]
    s_waitcnt vmcnt(5)
    ds_read_b64_tr_b16 a[144:145], v2 offset:8192
    ds_read_b64_tr_b16 a[146:147], v2 offset:9216
    v_mfma_f32_16x16x32_bf16 v[116:119], v[112:115], v[152:155], v[116:119]
    v_mfma_f32_32x32x16_bf16 v[192:207], v[156:159], a[184:187], v[192:207]
    ds_read_b64_tr_b16 v[140:141], v6 offset:53248
    ds_read_b64_tr_b16 v[142:143], v6 offset:53760
    s_add_u32 s90, s90, s98
    s_and_b32 s98, s79, 7
    s_lshl_b32 s98, s98, 7
    v_mfma_f32_32x32x16_bf16 v[208:223], v[156:159], a[188:191], v[208:223]
    s_waitcnt lgkmcnt(8)
    ds_read_b64_tr_b16 a[148:149], v28 offset:8192
    ds_read_b64_tr_b16 a[150:151], v28 offset:9216
    s_add_u32 s90, s90, s98
    s_lshl2_add_u32 s98, s79, s3
    v_mfma_f32_32x32x16_bf16 v[160:175], v[128:131], a[192:195], v[160:175]
    ds_read_b64_tr_b16 v[144:145], v5 offset:57344
    ds_read_b64_tr_b16 v[146:147], v5 offset:57856
    s_mul_i32 s89, s98, 147456
    s_lshl4_add_u32 s98, s98, s80
    s_add_u32 s41, s82, 1
    s_and_b32 s96, s41, 1
    s_and_b32 s41, s41, 6
    s_lshl1_add_u32 s41, s41, s96
    s_lshl_b32 s41, s41, 11
    v_mfma_f32_32x32x16_bf16 v[176:191], v[128:131], a[196:199], v[176:191]
    ds_read_b64_tr_b16 a[152:153], v2 offset:10240
    ds_read_b64_tr_b16 a[154:155], v2 offset:11264
    s_lshl_b32 s84, s98, 11
    s_add_u32 s84, s84, 1048576
    v_mfma_f32_16x16x32_bf16 v[116:119], v[112:115], v[128:131], v[116:119]
    v_mfma_f32_32x32x16_bf16 v[192:207], v[132:135], a[192:195], v[192:207]
    ds_read_b64_tr_b16 v[148:149], v6 offset:57344
    ds_read_b64_tr_b16 v[150:151], v6 offset:57856
    s_lshl_b32 s98, s80, 11
    s_add_u32 s89, s89, s98
    v_mfma_f32_32x32x16_bf16 v[208:223], v[132:135], a[196:199], v[208:223]
    s_waitcnt lgkmcnt(8)
    ds_read_b64_tr_b16 a[156:157], v28 offset:10240
    ds_read_b64_tr_b16 a[158:159], v28 offset:11264
    s_add_u32 s89, s89, 8503296
    s_mov_b32 s86, 0x4e800000
    v_mfma_f32_32x32x16_bf16 v[160:175], v[136:139], a[200:203], v[160:175]
    ds_read_b64_tr_b16 v[152:153], v5 offset:61440
    ds_read_b64_tr_b16 v[154:155], v5 offset:61952
    s_waitcnt vmcnt(0)
    v_cmp_ne_u32 vcc, s83, v30
    s_nop 0
    s_and_b32 vcc_lo, vcc_lo, 0x7f80
    s_mov_b32 vcc_hi, 0
    s_cbranch_vccnz L_pE_slow
L_pE_ok:
    v_mfma_f32_32x32x16_bf16 v[176:191], v[136:139], a[204:207], v[176:191]
    s_add_u32 s98, s100, s60
    buffer_load_dwordx4 v[48:51], v3, s[48:51], s98 offen offset:0 sc1
    v_mfma_f32_16x16x32_bf16 v[116:119], v[112:115], v[136:139], v[116:119]
    v_mfma_f32_32x32x16_bf16 v[192:207], v[140:143], a[200:203], v[192:207]
    ds_read_b64_tr_b16 v[156:157], v6 offset:61440
    ds_read_b64_tr_b16 v[158:159], v6 offset:61952
    buffer_load_dwordx4 v[52:55], v4, s[48:51], s98 offen offset:0 sc1
    v_mfma_f32_32x32x16_bf16 v[208:223], v[140:143], a[204:207], v[208:223]
    s_waitcnt lgkmcnt(6)
    buffer_load_dwordx4 v[56:59], v3, s[48:51], s98 offen offset:1024 sc1
    s_add_u32 s42, s82, 2
    s_and_b32 s96, s42, 1
    s_and_b32 s42, s42, 6
    s_lshl1_add_u32 s42, s42, s96
    s_lshl_b32 s42, s42, 11
    v_mfma_f32_32x32x16_bf16 v[160:175], v[144:147], a[208:211], v[160:175]
    s_barrier
    ds_read_b64_tr_b16 v[128:129], v5 offset:0
    ds_read_b64_tr_b16 v[130:131], v5 offset:512
    v_mfma_f32_32x32x16_bf16 v[176:191], v[144:147], a[212:215], v[176:191]
    buffer_load_dwordx4 v[60:63], v4, s[48:51], s98 offen offset:1024 sc1
    v_mfma_f32_16x16x32_bf16 v[116:119], v[112:115], v[144:147], v[116:119]
    v_mfma_f32_32x32x16_bf16 v[192:207], v[148:151], a[208:211], v[192:207]
    ds_read_b64_tr_b16 v[132:133], v6 offset:0
    ds_read_b64_tr_b16 v[134:135], v6 offset:512
    buffer_load_dwordx4 v[64:67], v3, s[48:51], s98 offen offset:2048 sc1
    v_mfma_f32_32x32x16_bf16 v[208:223], v[148:151], a[212:215], v[208:223]
    s_waitcnt lgkmcnt(4)
    buffer_load_dwordx4 v[68:71], v4, s[48:51], s98 offen offset:2048 sc1
    s_add_u32 s43, s82, 3
    s_and_b32 s96, s43, 1
    s_and_b32 s43, s43, 6
    s_lshl1_add_u32 s43, s43, s96
    s_lshl_b32 s43, s43, 11
    v_mfma_f32_32x32x16_bf16 v[160:175], v[152:155], a[216:219], v[160:175]
    ds_read_b64_tr_b16 v[136:137], v5 offset:4096
    ds_read_b64_tr_b16 v[138:139], v5 offset:4608
    buffer_load_dwordx4 v[72:75], v3, s[48:51], s98 offen offset:3072 sc1
    v_mfma_f32_32x32x16_bf16 v[176:191], v[152:155], a[220:223], v[176:191]
    buffer_load_dwordx4 v[76:79], v4, s[48:51], s98 offen offset:3072 sc1
    v_mfma_f32_16x16x32_bf16 v[116:119], v[112:115], v[152:155], v[116:119]
    v_mfma_f32_32x32x16_bf16 v[192:207], v[156:159], a[216:219], v[192:207]
    ds_read_b64_tr_b16 v[140:141], v6 offset:4096
    ds_read_b64_tr_b16 v[142:143], v6 offset:4608
    s_add_u32 s98, s100, s61
    buffer_load_dwordx4 v[80:83], v3, s[48:51], s98 offen offset:0 sc1
    v_mfma_f32_32x32x16_bf16 v[208:223], v[156:159], a[220:223], v[208:223]
    s_waitcnt lgkmcnt(4)
    buffer_load_dwordx4 v[84:87], v4, s[48:51], s98 offen offset:0 sc1
    s_add_u32 s44, s82, 4
    s_and_b32 s96, s44, 1
    s_and_b32 s44, s44, 6
    s_lshl1_add_u32 s44, s44, s96
    s_lshl_b32 s44, s44, 11
    v_mfma_f32_32x32x16_bf16 v[160:175], v[128:131], a[224:227], v[160:175]
    ds_read_b64_tr_b16 v[144:145], v5 offset:8192
    ds_read_b64_tr_b16 v[146:147], v5 offset:8704
    buffer_load_dwordx4 v[88:91], v3, s[48:51], s98 offen offset:1024 sc1
    v_mfma_f32_32x32x16_bf16 v[176:191], v[128:131], a[228:231], v[176:191]
    v_mfma_f32_16x16x32_bf16 v[116:119], v[112:115], v[128:131], v[116:119]
    v_mfma_f32_32x32x16_bf16 v[192:207], v[132:135], a[224:227], v[192:207]
    ds_read_b64_tr_b16 v[148:149], v6 offset:8192
    ds_read_b64_tr_b16 v[150:151], v6 offset:8704
    buffer_load_dwordx4 v[92:95], v4, s[48:51], s98 offen offset:1024 sc1
    s_add_u32 s45, s82, 5
    s_and_b32 s96, s45, 1
    s_and_b32 s45, s45, 6
    s_lshl1_add_u32 s45, s45, s96
    s_lshl_b32 s45, s45, 11
    v_mfma_f32_32x32x16_bf16 v[208:223], v[132:135], a[228:231], v[208:223]
    s_waitcnt lgkmcnt(4)
    v_mfma_f32_32x32x16_bf16 v[160:175], v[136:139], a[232:235], v[160:175]
    ds_read_b64_tr_b16 v[152:153], v5 offset:12288
    ds_read_b64_tr_b16 v[154:155], v5 offset:12800
    buffer_load_dwordx4 v[32:35], v3, s[48:51], s98 offen offset:2048 sc1
    s_waitcnt lgkmcnt(4)
    v_mfma_f32_16x16x32_bf16 v[116:119], v[112:115], v[144:147], v[116:119]
    v_mfma_f32_32x32x16_bf16 v[176:191], v[136:139], a[236:239], v[176:191]
    s_add_u32 s46, s82, 6
    s_and_b32 s96, s46, 1
    s_and_b32 s46, s46, 6
    s_lshl1_add_u32 s46, s46, s96
    s_lshl_b32 s46, s46, 11
    v_mfma_f32_16x16x32_bf16 v[116:119], v[112:115], v[136:139], v[116:119]
    v_mfma_f32_32x32x16_bf16 v[192:207], v[140:143], a[232:235], v[192:207]
    ds_read_b64_tr_b16 v[156:157], v6 offset:12288
    ds_read_b64_tr_b16 v[158:159], v6 offset:12800
    buffer_load_dwordx4 v[36:39], v4, s[48:51], s98 offen offset:2048 sc1
    v_mfma_f32_32x32x16_bf16 v[208:223], v[140:143], a[236:239], v[208:223]
    s_waitcnt lgkmcnt(4)
    v_mfma_f32_32x32x16_bf16 v[160:175], v[144:147], a[240:243], v[160:175]
    buffer_load_dword v30, v22, s[48:51], 0 offen sc1
    s_add_u32 s47, s82, 7
    s_and_b32 s96, s47, 1
    s_and_b32 s47, s47, 6
    s_lshl1_add_u32 s47, s47, s96
    s_lshl_b32 s47, s47, 11
    s_waitcnt lgkmcnt(2)
    v_mfma_f32_16x16x32_bf16 v[116:119], v[112:115], v[152:155], v[116:119]
    v_mfma_f32_32x32x16_bf16 v[176:191], v[144:147], a[244:247], v[176:191]
    buffer_load_dwordx4 v[40:43], v3, s[48:51], s98 offen offset:3072 sc1
    v_mfma_f32_32x32x16_bf16 v[192:207], v[148:151], a[240:243], v[192:207]
    buffer_load_dwordx4 v[44:47], v4, s[48:51], s98 offen offset:3072 sc1
    v_and_b32 v29, 256, v1
    v_cmp_eq_u32 vcc, 0, v29
    s_nop 3
    v_cndmask_b32 v96, v117, v116, vcc
    v_cvt_pk_bf16_f32 v29, v96, v96
    v_mfma_f32_32x32x16_bf16 v[208:223], v[148:151], a[244:247], v[208:223]
    s_waitcnt lgkmcnt(0)
    v_lshlrev_b32 v29, 16, v29
    v_sub_f32 v29, v96, v29
    v_cvt_pk_bf16_f32 v96, v96, v29
    ds_write_b32 v124, v96 offset:0
    v_mfma_f32_32x32x16_bf16 v[160:175], v[152:155], a[248:251], v[160:175]
    s_waitcnt lgkmcnt(0)
    s_barrier
    ds_read_b32 v100, v125 offset:0
    v_mfma_f32_32x32x16_bf16 v[176:191], v[152:155], a[252:255], v[176:191]
    v_mfma_f32_32x32x16_bf16 v[160:175], v[96:99], v[104:107], v[160:175]
    v_mfma_f32_32x32x16_bf16 v[192:207], v[156:159], a[248:251], v[192:207]
    v_mfma_f32_32x32x16_bf16 v[176:191], v[96:99], v[108:111], v[176:191]
    v_mfma_f32_32x32x16_bf16 v[208:223], v[156:159], a[252:255], v[208:223]
    s_waitcnt lgkmcnt(0)
    v_mfma_f32_32x32x16_bf16 v[192:207], v[100:103], v[104:107], v[192:207]
    v_mfma_f32_32x32x16_bf16 v[208:223], v[100:103], v[108:111], v[208:223]
    s_waitcnt vmcnt(16)
    v_mfma_f32_32x32x16_bf16 a[192:207], a[32:35], v[48:51], 0
    s_add_u32 s98, s100, s62
    buffer_load_dwordx4 v[96:99], v3, s[48:51], s98 offen offset:0 sc1
    v_mfma_f32_32x32x16_bf16 a[208:223], a[36:39], v[48:51], 0
    s_barrier
    s_waitcnt vmcnt(16)
    v_mfma_f32_32x32x16_bf16 a[224:239], a[32:35], v[52:55], 0
    buffer_load_dwordx4 v[100:103], v4, s[48:51], s98 offen offset:0 sc1
    ds_write_b64 v248, v[246:247]
    v_mul_f32 v24, v20, v160
    v_mul_f32 v25, v20, v161
    v_mul_f32 v26, v20, v162
    v_mul_f32 v27, v20, v163
    v_exp_f32 v24, v24
    v_exp_f32 v25, v25
    v_exp_f32 v26, v26
    v_mfma_f32_32x32x16_bf16 a[240:255], a[36:39], v[52:55], 0
    buffer_load_dwordx4 v[104:107], v3, s[48:51], s98 offen offset:1024 sc1
    v_exp_f32 v27, v27
    v_mul_f32 v168, v168, v160
    v_mul_f32 v169, v169, v161
    v_mul_f32 v170, v170, v162
    v_mul_f32 v171, v171, v163
    v_fma_f32 v24, v24, v21, v21
    v_fma_f32 v25, v25, v21, v21
    s_waitcnt vmcnt(17)
    v_mfma_f32_32x32x16_bf16 a[192:207], a[40:43], v[56:59], a[192:207]
    buffer_load_dwordx4 v[108:111], v4, s[48:51], s98 offen offset:1024 sc1
    v_fma_f32 v26, v26, v21, v21
    v_fma_f32 v27, v27, v21, v21
    v_rcp_f32 v24, v24
    v_rcp_f32 v25, v25
    v_rcp_f32 v26, v26
    v_rcp_f32 v27, v27
    v_mfma_f32_32x32x16_bf16 a[208:223], a[44:47], v[56:59], a[208:223]
    buffer_load_dwordx4 v[112:115], v3, s[48:51], s98 offen offset:2048 sc1
    v_mul_f32 v168, v168, v24
    v_mul_f32 v169, v169, v25
    v_mul_f32 v170, v170, v26
    v_mul_f32 v171, v171, v27
    v_cvt_pk_bf16_f32 v160, v168, v169
    v_cvt_pk_bf16_f32 v161, v170, v171
    v_mul_f32 v24, v20, v164
    v_mul_f32 v25, v20, v165
    v_mul_f32 v26, v20, v166
    s_waitcnt vmcnt(18)
    v_mfma_f32_32x32x16_bf16 a[224:239], a[40:43], v[60:63], a[224:239]
    buffer_load_dwordx4 v[116:119], v4, s[48:51], s98 offen offset:2048 sc1
    v_mul_f32 v27, v20, v167
    v_exp_f32 v24, v24
    v_exp_f32 v25, v25
    v_exp_f32 v26, v26
    v_exp_f32 v27, v27
    v_mfma_f32_32x32x16_bf16 a[240:255], a[44:47], v[60:63], a[240:255]
    v_mul_f32 v172, v172, v164
    v_mul_f32 v173, v173, v165
    v_mul_f32 v174, v174, v166
    v_mul_f32 v175, v175, v167
    v_fma_f32 v24, v24, v21, v21
    v_fma_f32 v25, v25, v21, v21
    v_fma_f32 v26, v26, v21, v21
    v_fma_f32 v27, v27, v21, v21
    v_rcp_f32 v24, v24
    s_waitcnt vmcnt(18)
    v_mfma_f32_32x32x16_bf16 a[192:207], a[48:51], v[64:67], a[192:207]
    buffer_load_dwordx4 v[120:123], v3, s[48:51], s98 offen offset:3072 sc1
    v_rcp_f32 v25, v25
    v_rcp_f32 v26, v26
    v_rcp_f32 v27, v27
    v_mul_f32 v172, v172, v24
    v_mul_f32 v173, v173, v25
    v_mul_f32 v174, v174, v26
    v_mul_f32 v175, v175, v27
    v_mfma_f32_32x32x16_bf16 a[208:223], a[52:55], v[64:67], a[208:223]
    v_cvt_pk_bf16_f32 v162, v172, v173
    v_cvt_pk_bf16_f32 v163, v174, v175
    s_xor_b32 s95, s88, 0
    buffer_store_dwordx4 v[160:163], v1, s[48:51], s95 offen sc1
    v_mul_f32 v24, v20, v192
    v_mul_f32 v25, v20, v193
    v_mul_f32 v26, v20, v194
    v_mul_f32 v27, v20, v195
    v_exp_f32 v24, v24
    s_waitcnt vmcnt(19)
    v_mfma_f32_32x32x16_bf16 a[224:239], a[48:51], v[68:71], a[224:239]
    buffer_load_dwordx4 v[124:127], v4, s[48:51], s98 offen offset:3072 sc1
    v_exp_f32 v25, v25
    v_exp_f32 v26, v26
    v_exp_f32 v27, v27
    v_mul_f32 v200, v200, v192
    v_mul_f32 v201, v201, v193
    v_mul_f32 v202, v202, v194
    v_mfma_f32_32x32x16_bf16 a[240:255], a[52:55], v[68:71], a[240:255]
    v_mul_f32 v203, v203, v195
    v_fma_f32 v24, v24, v21, v21
    v_fma_f32 v25, v25, v21, v21
    v_fma_f32 v26, v26, v21, v21
    v_fma_f32 v27, v27, v21, v21
    v_rcp_f32 v24, v24
    v_rcp_f32 v25, v25
    s_waitcnt vmcnt(19)
    v_mfma_f32_32x32x16_bf16 a[192:207], a[56:59], v[72:75], a[192:207]
    s_add_u32 m0, s87, 0
    s_lshl4_add_u32 s92, s42, s76
    buffer_load_dwordx4 v17, s[52:55], s92 offen offset:0 lds
    s_waitcnt vmcnt(12)
    v_cmp_ne_u32 vcc, s83, v30
    s_nop 0
    s_and_b64 vcc, vcc, s[0:1]
    s_cbranch_vccnz L_p1_slow
L_p1_ok:
    v_rcp_f32 v26, v26
    v_rcp_f32 v27, v27
    v_mul_f32 v200, v200, v24
    s_add_u32 s95, s93, 0
    s_lshl4_add_u32 s91, s95, s80
    s_lshl_b32 s91, s91, 12
    s_add_u32 s91, s91, 4194304
    v_mfma_f32_32x32x16_bf16 a[208:223], a[60:63], v[72:75], a[208:223]
    s_add_u32 m0, s94, 65536
    s_cmp_lt_i32 s95, 0
    s_cselect_b32 s91, 1073741824, s91
    buffer_load_dwordx4 v1, s[48:51], s91 offen offset:0 sc1 lds
    v_mul_f32 v201, v201, v25
    v_mul_f32 v202, v202, v26
    v_mul_f32 v203, v203, v27
    v_cvt_pk_bf16_f32 v192, v200, v201
    v_cvt_pk_bf16_f32 v193, v202, v203
    v_mul_f32 v24, v20, v196
    v_mfma_f32_32x32x16_bf16 a[224:239], a[56:59], v[76:79], a[224:239]
    buffer_load_dwordx4 v1, s[48:51], s91 offen offset:1024 sc1 lds
    v_mul_f32 v25, v20, v197
    v_mul_f32 v26, v20, v198
    v_mul_f32 v27, v20, v199
    v_exp_f32 v24, v24
    v_exp_f32 v25, v25
    v_exp_f32 v26, v26
    v_mfma_f32_32x32x16_bf16 a[240:255], a[60:63], v[76:79], a[240:255]
    buffer_load_dwordx4 v1, s[48:51], s91 offen offset:2048 sc1 lds
    v_exp_f32 v27, v27
    v_mul_f32 v204, v204, v196
    v_mul_f32 v205, v205, v197
    v_mul_f32 v206, v206, v198
    v_mul_f32 v207, v207, v199
    v_fma_f32 v24, v24, v21, v21
    v_fma_f32 v25, v25, v21, v21
    v_fma_f32 v26, v26, v21, v21
    v_mfma_f32_32x32x16_bf16 a[192:207], a[64:67], v[80:83], a[192:207]
    buffer_load_dwordx4 v1, s[48:51], s91 offen offset:3072 sc1 lds
    v_fma_f32 v27, v27, v21, v21
    v_rcp_f32 v24, v24
    v_rcp_f32 v25, v25
    v_rcp_f32 v26, v26
    s_add_u32 s95, s93, 1
    s_lshl4_add_u32 s91, s95, s80
    s_lshl_b32 s91, s91, 12
    s_add_u32 s91, s91, 4194304
    v_mfma_f32_32x32x16_bf16 a[208:223], a[68:71], v[80:83], a[208:223]
    s_add_u32 m0, s94, 69696
    s_cmp_lt_i32 s95, 0
    s_cselect_b32 s91, 1073741824, s91
    buffer_load_dwordx4 v1, s[48:51], s91 offen offset:0 sc1 lds
    v_rcp_f32 v27, v27
    v_mul_f32 v204, v204, v24
    v_mul_f32 v205, v205, v25
    v_mul_f32 v206, v206, v26
    v_mfma_f32_32x32x16_bf16 a[224:239], a[64:67], v[84:87], a[224:239]
    buffer_load_dwordx4 v1, s[48:51], s91 offen offset:1024 sc1 lds
    v_mul_f32 v207, v207, v27
    v_cvt_pk_bf16_f32 v194, v204, v205
    v_cvt_pk_bf16_f32 v195, v206, v207
    s_xor_b32 s95, s88, 1024
    buffer_store_dwordx4 v[192:195], v1, s[48:51], s95 offen sc1
    v_mul_f32 v24, v7, v176
    v_mul_f32 v25, v7, v177
    v_mul_f32 v26, v7, v178
    v_mul_f32 v27, v7, v179
    v_mfma_f32_32x32x16_bf16 a[240:255], a[68:71], v[84:87], a[240:255]
    buffer_load_dwordx4 v1, s[48:51], s91 offen offset:2048 sc1 lds
    v_exp_f32 v24, v24
    v_exp_f32 v25, v25
    v_exp_f32 v26, v26
    v_exp_f32 v27, v27
    v_mul_f32 v184, v184, v176
    v_mfma_f32_32x32x16_bf16 a[192:207], a[72:75], v[88:91], a[192:207]
    buffer_load_dwordx4 v1, s[48:51], s91 offen offset:3072 sc1 lds
    v_mul_f32 v185, v185, v177
    v_mul_f32 v186, v186, v178
    v_mul_f32 v187, v187, v179
    v_fma_f32 v24, v24, v8, v8
    v_fma_f32 v25, v25, v8, v8
    v_fma_f32 v26, v26, v8, v8
    s_add_u32 s95, s93, 2
    s_lshl4_add_u32 s91, s95, s80
    s_lshl_b32 s91, s91, 12
    s_add_u32 s91, s91, 4194304
    v_mfma_f32_32x32x16_bf16 a[208:223], a[76:79], v[88:91], a[208:223]
    s_add_u32 m0, s94, 73856
    s_cmp_lt_i32 s95, 0
    s_cselect_b32 s91, 1073741824, s91
    buffer_load_dwordx4 v1, s[48:51], s91 offen offset:0 sc1 lds
    v_fma_f32 v27, v27, v8, v8
    v_rcp_f32 v24, v24
    v_rcp_f32 v25, v25
    v_mfma_f32_32x32x16_bf16 a[224:239], a[72:75], v[92:95], a[224:239]
    buffer_load_dwordx4 v1, s[48:51], s91 offen offset:1024 sc1 lds
    v_rcp_f32 v26, v26
    v_rcp_f32 v27, v27
    v_mul_f32 v184, v184, v24
    v_mul_f32 v185, v185, v25
    v_mul_f32 v186, v186, v26
    v_mul_f32 v187, v187, v27
    v_cvt_pk_bf16_f32 v176, v184, v185
    v_cvt_pk_bf16_f32 v177, v186, v187
    v_mfma_f32_32x32x16_bf16 a[240:255], a[76:79], v[92:95], a[240:255]
    buffer_load_dwordx4 v1, s[48:51], s91 offen offset:2048 sc1 lds
    v_mul_f32 v24, v7, v180
    v_mul_f32 v25, v7, v181
    v_mul_f32 v26, v7, v182
    v_mul_f32 v27, v7, v183
    v_exp_f32 v24, v24
    v_exp_f32 v25, v25
    v_mfma_f32_32x32x16_bf16 a[192:207], a[80:83], v[32:35], a[192:207]
    buffer_load_dwordx4 v1, s[48:51], s91 offen offset:3072 sc1 lds
    v_exp_f32 v26, v26
    v_exp_f32 v27, v27
    v_mul_f32 v188, v188, v180
    v_mul_f32 v189, v189, v181
    v_mul_f32 v190, v190, v182
    v_mul_f32 v191, v191, v183
    v_fma_f32 v24, v24, v8, v8
    v_fma_f32 v25, v25, v8, v8
    v_mfma_f32_32x32x16_bf16 a[208:223], a[84:87], v[32:35], a[208:223]
    buffer_load_dwordx4 v[128:131], v1, s[48:51], s84 offen offset:0 sc1
    v_fma_f32 v26, v26, v8, v8
    v_fma_f32 v27, v27, v8, v8
    v_rcp_f32 v24, v24
    v_rcp_f32 v25, v25
    v_rcp_f32 v26, v26
    v_mfma_f32_32x32x16_bf16 a[224:239], a[80:83], v[36:39], a[224:239]
    buffer_load_dwordx4 v[132:135], v1, s[48:51], s84 offen offset:1024 sc1
    v_rcp_f32 v27, v27
    v_mul_f32 v188, v188, v24
    v_mul_f32 v189, v189, v25
    v_mul_f32 v190, v190, v26
    v_mul_f32 v191, v191, v27
    v_cvt_pk_bf16_f32 v178, v188, v189
    v_cvt_pk_bf16_f32 v179, v190, v191
    s_xor_b32 s95, s88, 0
    s_add_u32 s95, s95, 147456
    buffer_store_dwordx4 v[176:179], v1, s[48:51], s95 offen sc1
    v_mfma_f32_32x32x16_bf16 a[240:255], a[84:87], v[36:39], a[240:255]
    v_mul_f32 v24, v7, v208
    v_mul_f32 v25, v7, v209
    v_mul_f32 v26, v7, v210
    v_mul_f32 v27, v7, v211
    v_exp_f32 v24, v24
    v_exp_f32 v25, v25
    v_exp_f32 v26, v26
    s_waitcnt vmcnt(27)
    v_mfma_f32_32x32x16_bf16 a[192:207], a[88:91], v[40:43], a[192:207]
    s_add_u32 m0, s87, 0
    s_nop 0
    buffer_load_dwordx4 v18, s[52:55], s92 offen offset:1024 lds
    v_exp_f32 v27, v27
    v_mul_f32 v216, v216, v208
    v_mul_f32 v217, v217, v209
    v_mul_f32 v218, v218, v210
    v_mul_f32 v219, v219, v211
    v_fma_f32 v24, v24, v8, v8
    v_mfma_f32_32x32x16_bf16 a[208:223], a[92:95], v[40:43], a[208:223]
    v_fma_f32 v25, v25, v8, v8
    v_fma_f32 v26, v26, v8, v8
    v_fma_f32 v27, v27, v8, v8
    v_rcp_f32 v24, v24
    v_rcp_f32 v25, v25
    v_rcp_f32 v26, v26
    s_waitcnt vmcnt(27)
    v_mfma_f32_32x32x16_bf16 a[224:239], a[88:91], v[44:47], a[224:239]
    s_add_u32 m0, s87, 2048
    s_add_u32 s92, s92, 16384
    buffer_load_dwordx4 v17, s[52:55], s92 offen offset:0 lds
    v_rcp_f32 v27, v27
    v_mul_f32 v216, v216, v24
    v_mul_f32 v217, v217, v25
    v_mul_f32 v218, v218, v26
    v_mul_f32 v219, v219, v27
    v_cvt_pk_bf16_f32 v208, v216, v217
    v_cvt_pk_bf16_f32 v209, v218, v219
    v_mfma_f32_32x32x16_bf16 a[240:255], a[92:95], v[44:47], a[240:255]
    v_mul_f32 v24, v7, v212
    v_mul_f32 v25, v7, v213
    v_mul_f32 v26, v7, v214
    v_mul_f32 v27, v7, v215
    v_exp_f32 v24, v24
    v_exp_f32 v25, v25
    v_exp_f32 v26, v26
    s_waitcnt vmcnt(27)
    v_mfma_f32_32x32x16_bf16 a[192:207], a[96:99], v[96:99], a[192:207]
    buffer_load_dwordx4 v18, s[52:55], s92 offen offset:1024 lds
    v_exp_f32 v27, v27
    v_mul_f32 v220, v220, v212
    v_mul_f32 v221, v221, v213
    v_mul_f32 v222, v222, v214
    v_mul_f32 v223, v223, v215
    v_fma_f32 v24, v24, v8, v8
    v_fma_f32 v25, v25, v8, v8
    v_fma_f32 v26, v26, v8, v8
    v_fma_f32 v27, v27, v8, v8
    v_mfma_f32_32x32x16_bf16 a[208:223], a[100:103], v[96:99], a[208:223]
    v_rcp_f32 v24, v24
    v_rcp_f32 v25, v25
    v_rcp_f32 v26, v26
    v_rcp_f32 v27, v27
    v_mul_f32 v220, v220, v24
    s_waitcnt vmcnt(27)
    v_mfma_f32_32x32x16_bf16 a[224:239], a[96:99], v[100:103], a[224:239]
    s_add_u32 m0, s87, 4096
    s_lshl4_add_u32 s92, s43, s76
    buffer_load_dwordx4 v17, s[52:55], s92 offen offset:0 lds
    v_mul_f32 v221, v221, v25
    v_mul_f32 v222, v222, v26
    v_mul_f32 v223, v223, v27
    v_cvt_pk_bf16_f32 v210, v220, v221
    v_cvt_pk_bf16_f32 v211, v222, v223
    s_xor_b32 s95, s88, 1024
    s_add_u32 s95, s95, 147456
    buffer_store_dwordx4 v[208:211], v1, s[48:51], s95 offen sc1
    v_mfma_f32_32x32x16_bf16 a[240:255], a[100:103], v[100:103], a[240:255]
    s_waitcnt vmcnt(28)
    v_mfma_f32_32x32x16_bf16 a[192:207], a[104:107], v[104:107], a[192:207]
    buffer_load_dwordx4 v18, s[52:55], s92 offen offset:1024 lds
    v_mfma_f32_32x32x16_bf16 a[208:223], a[108:111], v[104:107], a[208:223]
    s_waitcnt vmcnt(28)
    v_mfma_f32_32x32x16_bf16 a[224:239], a[104:107], v[108:111], a[224:239]
    s_waitcnt vmcnt(9) lgkmcnt(0)
    s_barrier
    ds_read_b128 v[136:139], v236 offset:33280
    ds_read_b128 v[140:143], v236 offset:0
    v_mfma_f32_32x32x16_bf16 a[240:255], a[108:111], v[108:111], a[240:255]
    s_add_u32 m0, s87, 6144
    s_add_u32 s92, s92, 16384
    buffer_load_dwordx4 v17, s[52:55], s92 offen offset:0 lds
    ds_read_b64_tr_b16 v[240:241], v232 offset:33280
    ds_read_b64_tr_b16 v[242:243], v233 offset:33280
    ds_read_b64_tr_b16 v[244:245], v234 offset:33280
    ds_read_b64_tr_b16 v[246:247], v235 offset:33280
    v_mfma_f32_32x32x16_bf16 a[192:207], a[112:115], v[112:115], a[192:207]
    s_waitcnt vmcnt(8) lgkmcnt(5)
    v_mfma_f32_32x32x16_bf16 v[160:175], v[136:139], v[128:131], 0
    ds_read_b128 v[136:139], v236 offset:4160
    v_mfma_f32_32x32x16_bf16 a[208:223], a[116:119], v[112:115], a[208:223]
    buffer_load_dwordx4 v18, s[52:55], s92 offen offset:1024 lds
    s_waitcnt lgkmcnt(5)
    v_mfma_f32_32x32x16_bf16 v[192:207], v[140:143], v[128:131], 0
    v_mfma_f32_32x32x16_bf16 a[224:239], a[112:115], v[116:119], a[224:239]
    v_mfma_f32_32x32x16_bf16 a[240:255], a[116:119], v[116:119], a[240:255]
    v_mfma_f32_32x32x16_bf16 a[192:207], a[120:123], v[120:123], a[192:207]
    v_mfma_f32_32x32x16_bf16 a[208:223], a[124:127], v[120:123], a[208:223]
    v_mfma_f32_32x32x16_bf16 a[224:239], a[120:123], v[124:127], a[224:239]
    v_mfma_f32_32x32x16_bf16 a[240:255], a[124:127], v[124:127], a[240:255]
    s_nop 9
    v_cndmask_b32 v160, v192, v160, s[4:5]
    v_cndmask_b32 v161, v193, v161, s[6:7]
    v_cndmask_b32 v162, v194, v162, s[8:9]
    v_cndmask_b32 v163, v195, v163, s[10:11]
    v_cndmask_b32 v164, v196, v164, s[12:13]
    v_cndmask_b32 v165, v197, v165, s[14:15]
    v_cndmask_b32 v166, v198, v166, s[16:17]
    v_cndmask_b32 v167, v199, v167, s[18:19]
    v_cndmask_b32 v168, v200, v168, s[20:21]
    v_cndmask_b32 v169, v201, v169, s[22:23]
    v_cndmask_b32 v170, v202, v170, s[28:29]
    v_cndmask_b32 v171, v203, v171, s[30:31]
    v_cndmask_b32 v172, v204, v172, s[32:33]
    v_cndmask_b32 v173, v205, v173, s[34:35]
    v_cndmask_b32 v174, v206, v174, s[36:37]
    v_cndmask_b32 v175, v207, v175, s[38:39]
    s_waitcnt lgkmcnt(0)
    v_mfma_f32_32x32x16_bf16 v[176:191], v[136:139], v[128:131], 0
    ds_read_b128 v[136:139], v236 offset:8320
    s_add_u32 m0, s87, 8192
    s_lshl4_add_u32 s92, s44, s76
    buffer_load_dwordx4 v17, s[52:55], s92 offen offset:0 lds
    v_exp_f32 v160, v160
    v_exp_f32 v161, v161
    v_exp_f32 v162, v162
    v_exp_f32 v163, v163
    ds_read_b64_tr_b16 v[248:249], v232 offset:0
    ds_read_b64_tr_b16 v[250:251], v233 offset:0
    ds_read_b64_tr_b16 v[252:253], v234 offset:0
    ds_read_b64_tr_b16 v[254:255], v235 offset:0
    v_exp_f32 v164, v164
    v_exp_f32 v165, v165
    v_exp_f32 v166, v166
    v_exp_f32 v167, v167
    buffer_load_dwordx4 v18, s[52:55], s92 offen offset:1024 lds
    v_exp_f32 v168, v168
    v_exp_f32 v169, v169
    v_exp_f32 v170, v170
    v_exp_f32 v171, v171
    v_exp_f32 v172, v172
    v_exp_f32 v173, v173
    v_exp_f32 v174, v174
    v_exp_f32 v175, v175
    s_add_u32 m0, s87, 10240
    s_add_u32 s92, s92, 16384
    buffer_load_dwordx4 v17, s[52:55], s92 offen offset:0 lds
    s_waitcnt lgkmcnt(0)
    v_cvt_pk_bf16_f32 v144, v160, v161
    v_cvt_pk_bf16_f32 v145, v162, v163
    v_cvt_pk_bf16_f32 v146, v164, v165
    v_cvt_pk_bf16_f32 v147, v166, v167
    v_cvt_pk_bf16_f32 v148, v168, v169
    v_cvt_pk_bf16_f32 v149, v170, v171
    v_cvt_pk_bf16_f32 v150, v172, v173
    v_cvt_pk_bf16_f32 v151, v174, v175
    v_and_b32 v152, v144, v224
    v_and_b32 v153, v145, v225
    v_and_b32 v154, v146, v226
    v_and_b32 v155, v147, v227
    v_and_b32 v156, v148, v228
    v_and_b32 v157, v149, v229
    v_and_b32 v158, v150, v230
    v_and_b32 v159, v151, v231
    v_xor_b32 v144, v144, v152
    v_xor_b32 v145, v145, v153
    v_xor_b32 v146, v146, v154
    v_xor_b32 v147, v147, v155
    v_xor_b32 v148, v148, v156
    v_xor_b32 v149, v149, v157
    v_xor_b32 v150, v150, v158
    v_xor_b32 v151, v151, v159
    v_mfma_f32_32x32x16_bf16 v[160:175], v[136:139], v[128:131], 0
    ds_read_b128 v[136:139], v236 offset:12480
    buffer_load_dwordx4 v18, s[52:55], s92 offen offset:1024 lds
    v_exp_f32 v176, v176
    v_exp_f32 v177, v177
    v_exp_f32 v178, v178
    v_exp_f32 v179, v179
    v_mfma_f32_32x32x16_bf16 v[208:223], v[240:243], v[152:155], 0
    v_exp_f32 v180, v180
    v_exp_f32 v181, v181
    v_exp_f32 v182, v182
    v_exp_f32 v183, v183
    v_mfma_f32_32x32x16_bf16 v[208:223], v[244:247], v[156:159], v[208:223]
    ds_read_b64_tr_b16 v[240:241], v232 offset:4160
    ds_read_b64_tr_b16 v[242:243], v233 offset:4160
    s_add_u32 m0, s87, 12288
    s_lshl4_add_u32 s92, s45, s76
    buffer_load_dwordx4 v17, s[52:55], s92 offen offset:0 lds
    v_exp_f32 v184, v184
    v_exp_f32 v185, v185
    v_exp_f32 v186, v186
    v_exp_f32 v187, v187
    v_mfma_f32_32x32x16_bf16 v[208:223], v[248:251], v[144:147], v[208:223]
    ds_read_b64_tr_b16 v[244:245], v234 offset:4160
    ds_read_b64_tr_b16 v[246:247], v235 offset:4160
    v_exp_f32 v188, v188
    v_exp_f32 v189, v189
    v_exp_f32 v190, v190
    v_exp_f32 v191, v191
    v_mfma_f32_32x32x16_bf16 v[208:223], v[252:255], v[148:151], v[208:223]
    buffer_load_dwordx4 v18, s[52:55], s92 offen offset:1024 lds
    s_waitcnt lgkmcnt(0)
    v_cvt_pk_bf16_f32 v144, v176, v177
    v_cvt_pk_bf16_f32 v145, v178, v179
    v_cvt_pk_bf16_f32 v146, v180, v181
    v_cvt_pk_bf16_f32 v147, v182, v183
    v_cvt_pk_bf16_f32 v148, v184, v185
    v_cvt_pk_bf16_f32 v149, v186, v187
    v_cvt_pk_bf16_f32 v150, v188, v189
    v_cvt_pk_bf16_f32 v151, v190, v191
    v_mfma_f32_32x32x16_bf16 v[176:191], v[136:139], v[128:131], 0
    ds_read_b128 v[136:139], v236 offset:16640
    ds_read_b64_tr_b16 v[248:249], v232 offset:8320
    ds_read_b64_tr_b16 v[250:251], v233 offset:8320
    s_add_u32 m0, s87, 14336
    s_add_u32 s92, s92, 16384
    buffer_load_dwordx4 v17, s[52:55], s92 offen offset:0 lds
    v_exp_f32 v160, v160
    v_exp_f32 v161, v161
    v_exp_f32 v162, v162
    v_exp_f32 v163, v163
    v_mfma_f32_32x32x16_bf16 v[208:223], v[240:243], v[144:147], v[208:223]
    ds_read_b64_tr_b16 v[252:253], v234 offset:8320
    ds_read_b64_tr_b16 v[254:255], v235 offset:8320
    v_exp_f32 v164, v164
    v_exp_f32 v165, v165
    v_exp_f32 v166, v166
    v_exp_f32 v167, v167
    v_mfma_f32_32x32x16_bf16 v[208:223], v[244:247], v[148:151], v[208:223]
    buffer_load_dwordx4 v18, s[52:55], s92 offen offset:1024 lds
    v_exp_f32 v168, v168
    v_exp_f32 v169, v169
    v_exp_f32 v170, v170
    v_exp_f32 v171, v171
    v_exp_f32 v172, v172
    v_exp_f32 v173, v173
    v_exp_f32 v174, v174
    v_exp_f32 v175, v175
    s_add_u32 m0, s77, 0
    s_lshl4_add_u32 s92, s46, s76
    buffer_load_dwordx4 v17, s[52:55], s92 offen offset:0 lds
    s_waitcnt vmcnt(12)
    v_mov_b32 v23, s83
    buffer_store_dword v23, v19, s[48:51], 0 offen offset:4 sc1
    s_waitcnt lgkmcnt(0)
    v_cvt_pk_bf16_f32 v144, v160, v161
    v_cvt_pk_bf16_f32 v145, v162, v163
    v_cvt_pk_bf16_f32 v146, v164, v165
    v_cvt_pk_bf16_f32 v147, v166, v167
    v_cvt_pk_bf16_f32 v148, v168, v169
    v_cvt_pk_bf16_f32 v149, v170, v171
    v_cvt_pk_bf16_f32 v150, v172, v173
    v_cvt_pk_bf16_f32 v151, v174, v175
    v_mfma_f32_32x32x16_bf16 v[160:175], v[136:139], v[128:131], 0
    ds_read_b128 v[136:139], v236 offset:20800
    ds_read_b64_tr_b16 v[240:241], v232 offset:12480
    ds_read_b64_tr_b16 v[242:243], v233 offset:12480
    buffer_load_dwordx4 v18, s[52:55], s92 offen offset:1024 lds
    v_exp_f32 v176, v176
    v_exp_f32 v177, v177
    v_exp_f32 v178, v178
    v_exp_f32 v179, v179
    v_mfma_f32_32x32x16_bf16 v[208:223], v[248:251], v[144:147], v[208:223]
    ds_read_b64_tr_b16 v[244:245], v234 offset:12480
    ds_read_b64_tr_b16 v[246:247], v235 offset:12480
    v_exp_f32 v180, v180
    v_exp_f32 v181, v181
    v_exp_f32 v182, v182
    v_exp_f32 v183, v183
    v_mfma_f32_32x32x16_bf16 v[208:223], v[252:255], v[148:151], v[208:223]
    s_add_u32 m0, s77, 2048
    s_add_u32 s92, s92, 16384
    buffer_load_dwordx4 v17, s[52:55], s92 offen offset:0 lds
    ds_read_b64_tr_b16 a[160:161], v9 offset:0
    ds_read_b64_tr_b16 a[162:163], v9 offset:1024
    ds_read_b64_tr_b16 a[164:165], v10 offset:0
    ds_read_b64_tr_b16 a[166:167], v10 offset:1024
    v_exp_f32 v184, v184
    v_exp_f32 v185, v185
    v_exp_f32 v186, v186
    v_exp_f32 v187, v187
    ds_read_b64_tr_b16 a[168:169], v9 offset:2048
    ds_read_b64_tr_b16 a[170:171], v9 offset:3072
    ds_read_b64_tr_b16 a[172:173], v10 offset:2048
    ds_read_b64_tr_b16 a[174:175], v10 offset:3072
    v_exp_f32 v188, v188
    v_exp_f32 v189, v189
    v_exp_f32 v190, v190
    v_exp_f32 v191, v191
    buffer_load_dwordx4 v18, s[52:55], s92 offen offset:1024 lds
    s_waitcnt lgkmcnt(8)
    v_cvt_pk_bf16_f32 v144, v176, v177
    v_cvt_pk_bf16_f32 v145, v178, v179
    v_cvt_pk_bf16_f32 v146, v180, v181
    v_cvt_pk_bf16_f32 v147, v182, v183
    v_cvt_pk_bf16_f32 v148, v184, v185
    v_cvt_pk_bf16_f32 v149, v186, v187
    v_cvt_pk_bf16_f32 v150, v188, v189
    v_cvt_pk_bf16_f32 v151, v190, v191
    v_mfma_f32_32x32x16_bf16 v[176:191], v[136:139], v[128:131], 0
    ds_read_b128 v[136:139], v236 offset:24960
    ds_read_b64_tr_b16 v[248:249], v232 offset:16640
    ds_read_b64_tr_b16 v[250:251], v233 offset:16640
    s_add_u32 m0, s77, 4096
    s_lshl4_add_u32 s92, s47, s76
    buffer_load_dwordx4 v17, s[52:55], s92 offen offset:0 lds
    v_exp_f32 v160, v160
    v_exp_f32 v161, v161
    v_exp_f32 v162, v162
    v_exp_f32 v163, v163
    v_mfma_f32_32x32x16_bf16 v[208:223], v[240:243], v[144:147], v[208:223]
    ds_read_b64_tr_b16 v[252:253], v234 offset:16640
    ds_read_b64_tr_b16 v[254:255], v235 offset:16640
    v_exp_f32 v164, v164
    v_exp_f32 v165, v165
    v_exp_f32 v166, v166
    v_exp_f32 v167, v167
    v_mfma_f32_32x32x16_bf16 v[208:223], v[244:247], v[148:151], v[208:223]
    buffer_load_dwordx4 v18, s[52:55], s92 offen offset:1024 lds
    s_waitcnt vmcnt(15)
    ds_read_b64_tr_b16 a[176:177], v9 offset:4096
    ds_read_b64_tr_b16 a[178:179], v9 offset:5120
    ds_read_b64_tr_b16 a[180:181], v10 offset:4096
    ds_read_b64_tr_b16 a[182:183], v10 offset:5120
    v_exp_f32 v168, v168
    v_exp_f32 v169, v169
    v_exp_f32 v170, v170
    v_exp_f32 v171, v171
    ds_read_b64_tr_b16 a[184:185], v9 offset:6144
    ds_read_b64_tr_b16 a[186:187], v9 offset:7168
    ds_read_b64_tr_b16 a[188:189], v10 offset:6144
    ds_read_b64_tr_b16 a[190:191], v10 offset:7168
    v_exp_f32 v172, v172
    v_exp_f32 v173, v173
    v_exp_f32 v174, v174
    v_exp_f32 v175, v175
    s_add_u32 m0, s77, 6144
    s_add_u32 s92, s92, 16384
    buffer_load_dwordx4 v17, s[52:55], s92 offen offset:0 lds
    s_waitcnt lgkmcnt(8)
    v_cvt_pk_bf16_f32 v144, v160, v161
    v_cvt_pk_bf16_f32 v145, v162, v163
    v_cvt_pk_bf16_f32 v146, v164, v165
    v_cvt_pk_bf16_f32 v147, v166, v167
    v_cvt_pk_bf16_f32 v148, v168, v169
    v_cvt_pk_bf16_f32 v149, v170, v171
    v_cvt_pk_bf16_f32 v150, v172, v173
    v_cvt_pk_bf16_f32 v151, v174, v175
    v_mfma_f32_32x32x16_bf16 v[160:175], v[136:139], v[128:131], 0
    ds_read_b128 v[136:139], v236 offset:29120
    ds_read_b64_tr_b16 v[240:241], v232 offset:20800
    ds_read_b64_tr_b16 v[242:243], v233 offset:20800
    buffer_load_dwordx4 v18, s[52:55], s92 offen offset:1024 lds
    v_exp_f32 v176, v176
    v_exp_f32 v177, v177
    v_exp_f32 v178, v178
    v_exp_f32 v179, v179
    v_mfma_f32_32x32x16_bf16 v[208:223], v[248:251], v[144:147], v[208:223]
    ds_read_b64_tr_b16 v[244:245], v234 offset:20800
    ds_read_b64_tr_b16 v[246:247], v235 offset:20800
    v_exp_f32 v180, v180
    v_exp_f32 v181, v181
    v_exp_f32 v182, v182
    v_exp_f32 v183, v183
    v_mfma_f32_32x32x16_bf16 v[208:223], v[252:255], v[148:151], v[208:223]
    s_add_u32 m0, s87, 0
    s_add_u32 s92, s78, 0
    buffer_load_dwordx4 v17, s[56:59], s92 offen offset:0 lds
    s_waitcnt vmcnt(14)
    ds_read_b64_tr_b16 a[32:33], v9 offset:8192
    ds_read_b64_tr_b16 a[34:35], v9 offset:9216
    ds_read_b64_tr_b16 a[36:37], v10 offset:8192
    ds_read_b64_tr_b16 a[38:39], v10 offset:9216
    v_exp_f32 v184, v184
    v_exp_f32 v185, v185
    v_exp_f32 v186, v186
    v_exp_f32 v187, v187
    ds_read_b64_tr_b16 a[40:41], v9 offset:10240
    ds_read_b64_tr_b16 a[42:43], v9 offset:11264
    ds_read_b64_tr_b16 a[44:45], v10 offset:10240
    ds_read_b64_tr_b16 a[46:47], v10 offset:11264
    v_exp_f32 v188, v188
    v_exp_f32 v189, v189
    v_exp_f32 v190, v190
    v_exp_f32 v191, v191
    buffer_load_dwordx4 v18, s[56:59], s92 offen offset:1024 lds
    s_waitcnt lgkmcnt(8)
    v_cvt_pk_bf16_f32 v144, v176, v177
    v_cvt_pk_bf16_f32 v145, v178, v179
    v_cvt_pk_bf16_f32 v146, v180, v181
    v_cvt_pk_bf16_f32 v147, v182, v183
    v_cvt_pk_bf16_f32 v148, v184, v185
    v_cvt_pk_bf16_f32 v149, v186, v187
    v_cvt_pk_bf16_f32 v150, v188, v189
    v_cvt_pk_bf16_f32 v151, v190, v191
    v_mfma_f32_32x32x16_bf16 v[176:191], v[136:139], v[128:131], 0
    ds_read_b128 v[136:139], v236 offset:34304
    ds_read_b128 v[140:143], v236 offset:1024
    ds_read_b64_tr_b16 v[248:249], v232 offset:24960
    ds_read_b64_tr_b16 v[250:251], v233 offset:24960
    s_add_u32 m0, s87, 2048
    s_add_u32 s92, s92, 32768
    buffer_load_dwordx4 v17, s[56:59], s92 offen offset:0 lds
    v_exp_f32 v160, v160
    v_exp_f32 v161, v161
    v_exp_f32 v162, v162
    v_exp_f32 v163, v163
    v_mfma_f32_32x32x16_bf16 v[208:223], v[240:243], v[144:147], v[208:223]
    ds_read_b64_tr_b16 v[252:253], v234 offset:24960
    ds_read_b64_tr_b16 v[254:255], v235 offset:24960
    v_exp_f32 v164, v164
    v_exp_f32 v165, v165
    v_exp_f32 v166, v166
    v_exp_f32 v167, v167
    v_mfma_f32_32x32x16_bf16 v[208:223], v[244:247], v[148:151], v[208:223]
    buffer_load_dwordx4 v18, s[56:59], s92 offen offset:1024 lds
    s_waitcnt vmcnt(13)
    ds_read_b64_tr_b16 a[48:49], v9 offset:12288
    ds_read_b64_tr_b16 a[50:51], v9 offset:13312
    ds_read_b64_tr_b16 a[52:53], v10 offset:12288
    ds_read_b64_tr_b16 a[54:55], v10 offset:13312
    v_exp_f32 v168, v168
    v_exp_f32 v169, v169
    v_exp_f32 v170, v170
    v_exp_f32 v171, v171
    ds_read_b64_tr_b16 a[56:57], v9 offset:14336
    ds_read_b64_tr_b16 a[58:59], v9 offset:15360
    ds_read_b64_tr_b16 a[60:61], v10 offset:14336
    ds_read_b64_tr_b16 a[62:63], v10 offset:15360
    v_exp_f32 v172, v172
    v_exp_f32 v173, v173
    v_exp_f32 v174, v174
    v_exp_f32 v175, v175
    s_add_u32 m0, s87, 4096
    s_add_u32 s92, s78, 65536
    buffer_load_dwordx4 v17, s[56:59], s92 offen offset:0 lds
    s_waitcnt lgkmcnt(8)
    v_cvt_pk_bf16_f32 v144, v160, v161
    v_cvt_pk_bf16_f32 v145, v162, v163
    v_cvt_pk_bf16_f32 v146, v164, v165
    v_cvt_pk_bf16_f32 v147, v166, v167
    v_cvt_pk_bf16_f32 v148, v168, v169
    v_cvt_pk_bf16_f32 v149, v170, v171
    v_cvt_pk_bf16_f32 v150, v172, v173
    v_cvt_pk_bf16_f32 v151, v174, v175
    v_mfma_f32_32x32x16_bf16 v[160:175], v[136:139], v[132:135], 0
    ds_read_b128 v[136:139], v236 offset:5184
    ds_read_b64_tr_b16 v[240:241], v232 offset:29120
    ds_read_b64_tr_b16 v[242:243], v233 offset:29120
    buffer_load_dwordx4 v18, s[56:59], s92 offen offset:1024 lds
    v_exp_f32 v176, v176
    v_exp_f32 v177, v177
    v_exp_f32 v178, v178
    v_exp_f32 v179, v179
    v_mfma_f32_32x32x16_bf16 v[208:223], v[248:251], v[144:147], v[208:223]
    ds_read_b64_tr_b16 v[244:245], v234 offset:29120
    ds_read_b64_tr_b16 v[246:247], v235 offset:29120
    v_exp_f32 v180, v180
    v_exp_f32 v181, v181
    v_exp_f32 v182, v182
    v_exp_f32 v183, v183
    v_mfma_f32_32x32x16_bf16 v[208:223], v[252:255], v[148:151], v[208:223]
    s_add_u32 m0, s87, 6144
    s_add_u32 s92, s92, 32768
    buffer_load_dwordx4 v17, s[56:59], s92 offen offset:0 lds
    s_waitcnt vmcnt(11)
    ds_read_b64_tr_b16 a[64:65], v15 offset:0
    ds_read_b64_tr_b16 a[66:67], v15 offset:1024
    ds_read_b64_tr_b16 a[68:69], v16 offset:0
    ds_read_b64_tr_b16 a[70:71], v16 offset:1024
    v_exp_f32 v184, v184
    v_exp_f32 v185, v185
    v_exp_f32 v186, v186
    v_exp_f32 v187, v187
    v_mfma_f32_32x32x16_bf16 v[192:207], v[140:143], v[132:135], 0
    ds_read_b64_tr_b16 a[72:73], v15 offset:2048
    ds_read_b64_tr_b16 a[74:75], v15 offset:3072
    ds_read_b64_tr_b16 a[76:77], v16 offset:2048
    ds_read_b64_tr_b16 a[78:79], v16 offset:3072
    buffer_load_dword v30, v238, s[48:51], 0 offen offset:4 sc1
    v_exp_f32 v188, v188
    v_exp_f32 v189, v189
    v_exp_f32 v190, v190
    v_exp_f32 v191, v191
    buffer_load_dwordx4 v18, s[56:59], s92 offen offset:1024 lds
    s_waitcnt lgkmcnt(8)
    v_cvt_pk_bf16_f32 v144, v176, v177
    v_cvt_pk_bf16_f32 v145, v178, v179
    v_cvt_pk_bf16_f32 v146, v180, v181
    v_cvt_pk_bf16_f32 v147, v182, v183
    v_cvt_pk_bf16_f32 v148, v184, v185
    v_cvt_pk_bf16_f32 v149, v186, v187
    v_cvt_pk_bf16_f32 v150, v188, v189
    v_cvt_pk_bf16_f32 v151, v190, v191
    s_nop 0
    v_cndmask_b32 v160, v192, v160, s[4:5]
    v_mfma_f32_32x32x16_bf16 v[208:223], v[240:243], v[144:147], v[208:223]
    v_add_u32 v232, v232, v237
    v_add_u32 v233, v233, v237
    v_add_u32 v234, v234, v237
    v_add_u32 v235, v235, v237
    v_cndmask_b32 v161, v193, v161, s[6:7]
    v_cndmask_b32 v162, v194, v162, s[8:9]
    v_cndmask_b32 v163, v195, v163, s[10:11]
    v_cndmask_b32 v164, v196, v164, s[12:13]
    v_mfma_f32_32x32x16_bf16 v[208:223], v[244:247], v[148:151], v[208:223]
    ds_read_b64_tr_b16 v[240:241], v232 offset:33280
    ds_read_b64_tr_b16 v[242:243], v233 offset:33280
    ds_read_b64_tr_b16 v[244:245], v234 offset:33280
    ds_read_b64_tr_b16 v[246:247], v235 offset:33280
    v_cndmask_b32 v165, v197, v165, s[14:15]
    v_cndmask_b32 v166, v198, v166, s[16:17]
    v_cndmask_b32 v167, v199, v167, s[18:19]
    v_cndmask_b32 v168, v200, v168, s[20:21]
    v_cndmask_b32 v169, v201, v169, s[22:23]
    v_cndmask_b32 v170, v202, v170, s[28:29]
    v_cndmask_b32 v171, v203, v171, s[30:31]
    v_cndmask_b32 v172, v204, v172, s[32:33]
    v_cndmask_b32 v173, v205, v173, s[34:35]
    v_cndmask_b32 v174, v206, v174, s[36:37]
    v_cndmask_b32 v175, v207, v175, s[38:39]
    v_cmp_le_f32 vcc, 0x21800000, v216
    v_cmp_ge_f32 s[96:97], s86, v216
    v_rcp_f32 v24, v216
    s_and_b64 vcc, vcc, s[96:97]
    s_cmp_eq_u64 vcc, exec
    s_cbranch_scc0 L_f0_slow
L_f0_ok:
    v_pk_mul_f32 v[208:209], v[208:209], v[24:25] op_sel_hi:[1,0]
    v_pk_mul_f32 v[210:211], v[210:211], v[24:25] op_sel_hi:[1,0]
    v_pk_mul_f32 v[212:213], v[212:213], v[24:25] op_sel_hi:[1,0]
    v_pk_mul_f32 v[214:215], v[214:215], v[24:25] op_sel_hi:[1,0]
    v_cvt_pk_bf16_f32 v152, v208, v209
    v_cvt_pk_bf16_f32 v153, v210, v211
    v_cvt_pk_bf16_f32 v154, v212, v213
    v_cvt_pk_bf16_f32 v155, v214, v215
    buffer_store_dwordx4 v[152:155], v1, s[48:51], s89 offen offset:0 sc1
    v_mfma_f32_32x32x16_bf16 v[176:191], v[136:139], v[132:135], 0
    ds_read_b128 v[136:139], v236 offset:9344
    s_add_u32 m0, s87, 8192
    s_add_u32 s92, s78, 16384
    buffer_load_dwordx4 v17, s[56:59], s92 offen offset:0 lds
    v_exp_f32 v160, v160
    v_exp_f32 v161, v161
    v_exp_f32 v162, v162
    v_exp_f32 v163, v163
    ds_read_b64_tr_b16 v[248:249], v232 offset:0
    ds_read_b64_tr_b16 v[250:251], v233 offset:0
    ds_read_b64_tr_b16 v[252:253], v234 offset:0
    ds_read_b64_tr_b16 v[254:255], v235 offset:0
    v_exp_f32 v164, v164
    v_exp_f32 v165, v165
    v_exp_f32 v166, v166
    v_exp_f32 v167, v167
    buffer_load_dwordx4 v18, s[56:59], s92 offen offset:1024 lds
    v_exp_f32 v168, v168
    v_exp_f32 v169, v169
    v_exp_f32 v170, v170
    v_exp_f32 v171, v171
    v_exp_f32 v172, v172
    v_exp_f32 v173, v173
    v_exp_f32 v174, v174
    v_exp_f32 v175, v175
    s_add_u32 m0, s87, 10240
    s_add_u32 s92, s92, 32768
    buffer_load_dwordx4 v17, s[56:59], s92 offen offset:0 lds
    s_waitcnt lgkmcnt(0)
    v_cvt_pk_bf16_f32 v144, v160, v161
    v_cvt_pk_bf16_f32 v145, v162, v163
    v_cvt_pk_bf16_f32 v146, v164, v165
    v_cvt_pk_bf16_f32 v147, v166, v167
    v_cvt_pk_bf16_f32 v148, v168, v169
    v_cvt_pk_bf16_f32 v149, v170, v171
    v_cvt_pk_bf16_f32 v150, v172, v173
    v_cvt_pk_bf16_f32 v151, v174, v175
    v_and_b32 v152, v144, v224
    v_and_b32 v153, v145, v225
    v_and_b32 v154, v146, v226
    v_and_b32 v155, v147, v227
    v_and_b32 v156, v148, v228
    v_and_b32 v157, v149, v229
    v_and_b32 v158, v150, v230
    v_and_b32 v159, v151, v231
    v_xor_b32 v144, v144, v152
    v_xor_b32 v145, v145, v153
    v_xor_b32 v146, v146, v154
    v_xor_b32 v147, v147, v155
    v_xor_b32 v148, v148, v156
    v_xor_b32 v149, v149, v157
    v_xor_b32 v150, v150, v158
    v_xor_b32 v151, v151, v159
    v_mfma_f32_32x32x16_bf16 v[160:175], v[136:139], v[132:135], 0
    ds_read_b128 v[136:139], v236 offset:13504
    buffer_load_dwordx4 v18, s[56:59], s92 offen offset:1024 lds
    v_exp_f32 v176, v176
    v_exp_f32 v177, v177
    v_exp_f32 v178, v178
    v_exp_f32 v179, v179
    v_mfma_f32_32x32x16_bf16 v[208:223], v[240:243], v[152:155], 0
    v_exp_f32 v180, v180
    v_exp_f32 v181, v181
    v_exp_f32 v182, v182
    v_exp_f32 v183, v183
    v_mfma_f32_32x32x16_bf16 v[208:223], v[244:247], v[156:159], v[208:223]
    ds_read_b64_tr_b16 v[240:241], v232 offset:4160
    ds_read_b64_tr_b16 v[242:243], v233 offset:4160
    s_add_u32 m0, s87, 12288
    s_add_u32 s92, s78, 81920
    buffer_load_dwordx4 v17, s[56:59], s92 offen offset:0 lds
    v_exp_f32 v184, v184
    v_exp_f32 v185, v185
    v_exp_f32 v186, v186
    v_exp_f32 v187, v187
    v_mfma_f32_32x32x16_bf16 v[208:223], v[248:251], v[144:147], v[208:223]
    ds_read_b64_tr_b16 v[244:245], v234 offset:4160
    ds_read_b64_tr_b16 v[246:247], v235 offset:4160
    v_exp_f32 v188, v188
    v_exp_f32 v189, v189
    v_exp_f32 v190, v190
    v_exp_f32 v191, v191
    v_mfma_f32_32x32x16_bf16 v[208:223], v[252:255], v[148:151], v[208:223]
    buffer_load_dwordx4 v18, s[56:59], s92 offen offset:1024 lds
    s_waitcnt lgkmcnt(0)
    v_cvt_pk_bf16_f32 v144, v176, v177
    v_cvt_pk_bf16_f32 v145, v178, v179
    v_cvt_pk_bf16_f32 v146, v180, v181
    v_cvt_pk_bf16_f32 v147, v182, v183
    v_cvt_pk_bf16_f32 v148, v184, v185
    v_cvt_pk_bf16_f32 v149, v186, v187
    v_cvt_pk_bf16_f32 v150, v188, v189
    v_cvt_pk_bf16_f32 v151, v190, v191
    v_mfma_f32_32x32x16_bf16 v[176:191], v[136:139], v[132:135], 0
    ds_read_b128 v[136:139], v236 offset:17664
    ds_read_b64_tr_b16 v[248:249], v232 offset:8320
    ds_read_b64_tr_b16 v[250:251], v233 offset:8320
    s_add_u32 m0, s87, 14336
    s_add_u32 s92, s92, 32768
    buffer_load_dwordx4 v17, s[56:59], s92 offen offset:0 lds
    v_exp_f32 v160, v160
    v_exp_f32 v161, v161
    v_exp_f32 v162, v162
    v_exp_f32 v163, v163
    v_mfma_f32_32x32x16_bf16 v[208:223], v[240:243], v[144:147], v[208:223]
    ds_read_b64_tr_b16 v[252:253], v234 offset:8320
    ds_read_b64_tr_b16 v[254:255], v235 offset:8320
    v_exp_f32 v164, v164
    v_exp_f32 v165, v165
    v_exp_f32 v166, v166
    v_exp_f32 v167, v167
    v_mfma_f32_32x32x16_bf16 v[208:223], v[244:247], v[148:151], v[208:223]
    buffer_load_dwordx4 v18, s[56:59], s92 offen offset:1024 lds
    v_exp_f32 v168, v168
    v_exp_f32 v169, v169
    v_exp_f32 v170, v170
    v_exp_f32 v171, v171
    v_exp_f32 v172, v172
    v_exp_f32 v173, v173
    v_exp_f32 v174, v174
    v_exp_f32 v175, v175
    s_waitcnt vmcnt(8)
    v_mov_b32 v23, s83
    buffer_store_dword v23, v19, s[48:51], 0 offen offset:8 sc1
    s_waitcnt lgkmcnt(0)
    v_cvt_pk_bf16_f32 v144, v160, v161
    v_cvt_pk_bf16_f32 v145, v162, v163
    v_cvt_pk_bf16_f32 v146, v164, v165
    v_cvt_pk_bf16_f32 v147, v166, v167
    v_cvt_pk_bf16_f32 v148, v168, v169
    v_cvt_pk_bf16_f32 v149, v170, v171
    v_cvt_pk_bf16_f32 v150, v172, v173
    v_cvt_pk_bf16_f32 v151, v174, v175
    v_mfma_f32_32x32x16_bf16 v[160:175], v[136:139], v[132:135], 0
    ds_read_b128 v[136:139], v236 offset:21824
    ds_read_b64_tr_b16 v[240:241], v232 offset:12480
    ds_read_b64_tr_b16 v[242:243], v233 offset:12480
    v_exp_f32 v176, v176
    v_exp_f32 v177, v177
    v_exp_f32 v178, v178
    v_exp_f32 v179, v179
    v_mfma_f32_32x32x16_bf16 v[208:223], v[248:251], v[144:147], v[208:223]
    ds_read_b64_tr_b16 v[244:245], v234 offset:12480
    ds_read_b64_tr_b16 v[246:247], v235 offset:12480
    v_exp_f32 v180, v180
    v_exp_f32 v181, v181
    v_exp_f32 v182, v182
    v_exp_f32 v183, v183
    v_mfma_f32_32x32x16_bf16 v[208:223], v[252:255], v[148:151], v[208:223]
    v_exp_f32 v184, v184
    v_exp_f32 v185, v185
    v_exp_f32 v186, v186
    v_exp_f32 v187, v187
    v_exp_f32 v188, v188
    v_exp_f32 v189, v189
    v_exp_f32 v190, v190
    v_exp_f32 v191, v191
    v_cmp_ne_u32 vcc, s83, v30
    s_nop 0
    s_cbranch_vccnz L_pH_slow
L_pH_ok:
    s_waitcnt lgkmcnt(0)
    v_cvt_pk_bf16_f32 v144, v176, v177
    v_cvt_pk_bf16_f32 v145, v178, v179
    v_cvt_pk_bf16_f32 v146, v180, v181
    v_cvt_pk_bf16_f32 v147, v182, v183
    v_cvt_pk_bf16_f32 v148, v184, v185
    v_cvt_pk_bf16_f32 v149, v186, v187
    v_cvt_pk_bf16_f32 v150, v188, v189
    v_cvt_pk_bf16_f32 v151, v190, v191
    v_mfma_f32_32x32x16_bf16 v[176:191], v[136:139], v[132:135], 0
    ds_read_b128 v[136:139], v236 offset:25984
    ds_read_b64_tr_b16 v[248:249], v232 offset:16640
    ds_read_b64_tr_b16 v[250:251], v233 offset:16640
    s_add_u32 s98, s100, s40
    buffer_load_dwordx4 v[48:51], v3, s[48:51], s98 offen offset:0 sc1
    v_exp_f32 v160, v160
    v_exp_f32 v161, v161
    v_exp_f32 v162, v162
    v_exp_f32 v163, v163
    v_mfma_f32_32x32x16_bf16 v[208:223], v[240:243], v[144:147], v[208:223]
    ds_read_b64_tr_b16 v[252:253], v234 offset:16640
    ds_read_b64_tr_b16 v[254:255], v235 offset:16640
    v_exp_f32 v164, v164
    v_exp_f32 v165, v165
    v_exp_f32 v166, v166
    v_exp_f32 v167, v167
    v_mfma_f32_32x32x16_bf16 v[208:223], v[244:247], v[148:151], v[208:223]
    buffer_load_dwordx4 v[52:55], v4, s[48:51], s98 offen offset:0 sc1
    v_exp_f32 v168, v168
    v_exp_f32 v169, v169
    v_exp_f32 v170, v170
    v_exp_f32 v171, v171
    v_exp_f32 v172, v172
    v_exp_f32 v173, v173
    v_exp_f32 v174, v174
    v_exp_f32 v175, v175
    buffer_load_dwordx4 v[56:59], v3, s[48:51], s98 offen offset:1024 sc1
    s_waitcnt lgkmcnt(0)
    v_cvt_pk_bf16_f32 v144, v160, v161
    v_cvt_pk_bf16_f32 v145, v162, v163
    v_cvt_pk_bf16_f32 v146, v164, v165
    v_cvt_pk_bf16_f32 v147, v166, v167
    v_cvt_pk_bf16_f32 v148, v168, v169
    v_cvt_pk_bf16_f32 v149, v170, v171
    v_cvt_pk_bf16_f32 v150, v172, v173
    v_cvt_pk_bf16_f32 v151, v174, v175
    v_mfma_f32_32x32x16_bf16 v[160:175], v[136:139], v[132:135], 0
    ds_read_b128 v[136:139], v236 offset:30144
    ds_read_b64_tr_b16 v[240:241], v232 offset:20800
    ds_read_b64_tr_b16 v[242:243], v233 offset:20800
    buffer_load_dwordx4 v[60:63], v4, s[48:51], s98 offen offset:1024 sc1
    v_exp_f32 v176, v176
    v_exp_f32 v177, v177
    v_exp_f32 v178, v178
    v_exp_f32 v179, v179
    v_mfma_f32_32x32x16_bf16 v[208:223], v[248:251], v[144:147], v[208:223]
    ds_read_b64_tr_b16 v[244:245], v234 offset:20800
    ds_read_b64_tr_b16 v[246:247], v235 offset:20800
    v_exp_f32 v180, v180
    v_exp_f32 v181, v181
    v_exp_f32 v182, v182
    v_exp_f32 v183, v183
    v_mfma_f32_32x32x16_bf16 v[208:223], v[252:255], v[148:151], v[208:223]
    s_add_u32 s98, s100, s41
    buffer_load_dwordx4 v[64:67], v3, s[48:51], s98 offen offset:0 sc1
    v_exp_f32 v184, v184
    v_exp_f32 v185, v185
    v_exp_f32 v186, v186
    v_exp_f32 v187, v187
    v_exp_f32 v188, v188
    v_exp_f32 v189, v189
    v_exp_f32 v190, v190
    v_exp_f32 v191, v191
    buffer_load_dwordx4 v[68:71], v4, s[48:51], s98 offen offset:0 sc1
    s_waitcnt lgkmcnt(0)
    v_cvt_pk_bf16_f32 v144, v176, v177
    v_cvt_pk_bf16_f32 v145, v178, v179
    v_cvt_pk_bf16_f32 v146, v180, v181
    v_cvt_pk_bf16_f32 v147, v182, v183
    v_cvt_pk_bf16_f32 v148, v184, v185
    v_cvt_pk_bf16_f32 v149, v186, v187
    v_cvt_pk_bf16_f32 v150, v188, v189
    v_cvt_pk_bf16_f32 v151, v190, v191
    v_mfma_f32_32x32x16_bf16 v[176:191], v[136:139], v[132:135], 0
    ds_read_b64_tr_b16 v[248:249], v232 offset:24960
    ds_read_b64_tr_b16 v[250:251], v233 offset:24960
    buffer_load_dwordx4 v[72:75], v3, s[48:51], s98 offen offset:1024 sc1
    v_exp_f32 v160, v160
    v_exp_f32 v161, v161
    v_exp_f32 v162, v162
    v_exp_f32 v163, v163
    v_mfma_f32_32x32x16_bf16 v[208:223], v[240:243], v[144:147], v[208:223]
    ds_read_b64_tr_b16 v[252:253], v234 offset:24960
    ds_read_b64_tr_b16 v[254:255], v235 offset:24960
    v_exp_f32 v164, v164
    v_exp_f32 v165, v165
    v_exp_f32 v166, v166
    v_exp_f32 v167, v167
    v_mfma_f32_32x32x16_bf16 v[208:223], v[244:247], v[148:151], v[208:223]
    buffer_load_dwordx4 v[76:79], v4, s[48:51], s98 offen offset:1024 sc1
    v_exp_f32 v168, v168
    v_exp_f32 v169, v169
    v_exp_f32 v170, v170
    v_exp_f32 v171, v171
    v_exp_f32 v172, v172
    v_exp_f32 v173, v173
    v_exp_f32 v174, v174
    v_exp_f32 v175, v175
    s_add_u32 s98, s100, s42
    buffer_load_dwordx4 v[80:83], v3, s[48:51], s98 offen offset:0 sc1
    s_waitcnt lgkmcnt(0)
    v_cvt_pk_bf16_f32 v144, v160, v161
    v_cvt_pk_bf16_f32 v145, v162, v163
    v_cvt_pk_bf16_f32 v146, v164, v165
    v_cvt_pk_bf16_f32 v147, v166, v167
    v_cvt_pk_bf16_f32 v148, v168, v169
    v_cvt_pk_bf16_f32 v149, v170, v171
    v_cvt_pk_bf16_f32 v150, v172, v173
    v_cvt_pk_bf16_f32 v151, v174, v175
    ds_read_b64_tr_b16 v[240:241], v232 offset:29120
    ds_read_b64_tr_b16 v[242:243], v233 offset:29120
    buffer_load_dwordx4 v[84:87], v4, s[48:51], s98 offen offset:0 sc1
    v_exp_f32 v176, v176
    v_exp_f32 v177, v177
    v_exp_f32 v178, v178
    v_exp_f32 v179, v179
    v_mfma_f32_32x32x16_bf16 v[208:223], v[248:251], v[144:147], v[208:223]
    ds_read_b64_tr_b16 v[244:245], v234 offset:29120
    ds_read_b64_tr_b16 v[246:247], v235 offset:29120
    v_exp_f32 v180, v180
    v_exp_f32 v181, v181
    v_exp_f32 v182, v182
    v_exp_f32 v183, v183
    v_mfma_f32_32x32x16_bf16 v[208:223], v[252:255], v[148:151], v[208:223]
    buffer_load_dwordx4 v[88:91], v3, s[48:51], s98 offen offset:1024 sc1
    v_exp_f32 v184, v184
    v_exp_f32 v185, v185
    v_exp_f32 v186, v186
    v_exp_f32 v187, v187
    buffer_load_dword v29, v238, s[48:51], 0 offen offset:8 sc1
    v_exp_f32 v188, v188
    v_exp_f32 v189, v189
    v_exp_f32 v190, v190
    v_exp_f32 v191, v191
    buffer_load_dwordx4 v[92:95], v4, s[48:51], s98 offen offset:1024 sc1
    s_waitcnt lgkmcnt(0)
    v_cvt_pk_bf16_f32 v144, v176, v177
    v_cvt_pk_bf16_f32 v145, v178, v179
    v_cvt_pk_bf16_f32 v146, v180, v181
    v_cvt_pk_bf16_f32 v147, v182, v183
    v_cvt_pk_bf16_f32 v148, v184, v185
    v_cvt_pk_bf16_f32 v149, v186, v187
    v_cvt_pk_bf16_f32 v150, v188, v189
    v_cvt_pk_bf16_f32 v151, v190, v191
    s_nop 1
    v_mfma_f32_32x32x16_bf16 v[208:223], v[240:243], v[144:147], v[208:223]
    v_mov_b32 v22, v238
    v_mfma_f32_32x32x16_bf16 v[208:223], v[244:247], v[148:151], v[208:223]
    s_nop 11
    v_cmp_le_f32 vcc, 0x21800000, v216
    v_cmp_ge_f32 s[96:97], s86, v216
    v_rcp_f32 v24, v216
    s_and_b64 vcc, vcc, s[96:97]
    s_cmp_eq_u64 vcc, exec
    s_cbranch_scc0 L_f1_slow
L_f1_ok:
    v_pk_mul_f32 v[208:209], v[208:209], v[24:25] op_sel_hi:[1,0]
    v_pk_mul_f32 v[210:211], v[210:211], v[24:25] op_sel_hi:[1,0]
    v_pk_mul_f32 v[212:213], v[212:213], v[24:25] op_sel_hi:[1,0]
    v_pk_mul_f32 v[214:215], v[214:215], v[24:25] op_sel_hi:[1,0]
    v_cvt_pk_bf16_f32 v152, v208, v209
    v_cvt_pk_bf16_f32 v153, v210, v211
    v_cvt_pk_bf16_f32 v154, v212, v213
    v_cvt_pk_bf16_f32 v155, v214, v215
    buffer_store_dwordx4 v[152:155], v1, s[48:51], s89 offen offset:1024 sc1
    s_add_u32 s98, s100, s43
    buffer_load_dwordx4 v[32:35], v3, s[48:51], s98 offen offset:0 sc1
    buffer_load_dwordx4 v[36:39], v4, s[48:51], s98 offen offset:0 sc1
    s_waitcnt vmcnt(15)
    v_mfma_f32_32x32x16_bf16 a[192:207], a[128:131], v[48:51], a[192:207]
    ds_read_b64_tr_b16 a[0:1], v9 offset:0
    ds_read_b64_tr_b16 a[2:3], v9 offset:1024
    buffer_load_dwordx4 v[40:43], v3, s[48:51], s98 offen offset:1024 sc1
    v_mfma_f32_32x32x16_bf16 a[208:223], a[132:135], v[48:51], a[208:223]
    ds_read_b64_tr_b16 a[4:5], v10 offset:0
    ds_read_b64_tr_b16 a[6:7], v10 offset:1024
    buffer_load_dwordx4 v[44:47], v4, s[48:51], s98 offen offset:1024 sc1
    s_waitcnt vmcnt(16)
    v_mfma_f32_32x32x16_bf16 a[224:239], a[128:131], v[52:55], a[224:239]
    ds_read_b64_tr_b16 a[8:9], v9 offset:2048
    ds_read_b64_tr_b16 a[10:11], v9 offset:3072
    s_add_u32 s98, s100, s44
    buffer_load_dwordx4 v[96:99], v3, s[48:51], s98 offen offset:0 sc1
    v_mfma_f32_32x32x16_bf16 a[240:255], a[132:135], v[52:55], a[240:255]
    ds_read_b64_tr_b16 a[12:13], v10 offset:2048
    ds_read_b64_tr_b16 a[14:15], v10 offset:3072
    buffer_load_dwordx4 v[100:103], v4, s[48:51], s98 offen offset:0 sc1
    s_waitcnt vmcnt(17)
    v_mfma_f32_32x32x16_bf16 a[192:207], a[136:139], v[56:59], a[192:207]
    ds_read_b64_tr_b16 a[16:17], v9 offset:4096
    ds_read_b64_tr_b16 a[18:19], v9 offset:5120
    buffer_load_dwordx4 v[104:107], v3, s[48:51], s98 offen offset:1024 sc1
    v_mfma_f32_32x32x16_bf16 a[208:223], a[140:143], v[56:59], a[208:223]
    ds_read_b64_tr_b16 a[20:21], v10 offset:4096
    ds_read_b64_tr_b16 a[22:23], v10 offset:5120
    buffer_load_dwordx4 v[108:111], v4, s[48:51], s98 offen offset:1024 sc1
    s_waitcnt vmcnt(18)
    v_mfma_f32_32x32x16_bf16 a[224:239], a[136:139], v[60:63], a[224:239]
    ds_read_b64_tr_b16 a[24:25], v9 offset:6144
    ds_read_b64_tr_b16 a[26:27], v9 offset:7168
    s_add_u32 s98, s100, s45
    buffer_load_dwordx4 v[112:115], v3, s[48:51], s98 offen offset:0 sc1
    v_mfma_f32_32x32x16_bf16 a[240:255], a[140:143], v[60:63], a[240:255]
    ds_read_b64_tr_b16 a[28:29], v10 offset:6144
    ds_read_b64_tr_b16 a[30:31], v10 offset:7168
    buffer_load_dwordx4 v[116:119], v4, s[48:51], s98 offen offset:0 sc1
    s_waitcnt vmcnt(19)
    v_mfma_f32_32x32x16_bf16 a[192:207], a[144:147], v[64:67], a[192:207]
    ds_read_b64_tr_b16 a[80:81], v15 offset:4096
    ds_read_b64_tr_b16 a[82:83], v15 offset:5120
    buffer_load_dwordx4 v[120:123], v3, s[48:51], s98 offen offset:1024 sc1
    v_mfma_f32_32x32x16_bf16 a[208:223], a[148:151], v[64:67], a[208:223]
    ds_read_b64_tr_b16 a[84:85], v16 offset:4096
    ds_read_b64_tr_b16 a[86:87], v16 offset:5120
    buffer_load_dwordx4 v[124:127], v4, s[48:51], s98 offen offset:1024 sc1
    s_waitcnt vmcnt(20)
    v_mfma_f32_32x32x16_bf16 a[224:239], a[144:147], v[68:71], a[224:239]
    ds_read_b64_tr_b16 a[88:89], v15 offset:6144
    ds_read_b64_tr_b16 a[90:91], v15 offset:7168
    s_add_u32 s98, s100, s46
    buffer_load_dwordx4 v[128:131], v3, s[48:51], s98 offen offset:0 sc1
    s_waitcnt vmcnt(15)
    v_cmp_ne_u32 vcc, s83, v29
    s_nop 0
    s_cbranch_vccnz L_pO_slow
L_pO_ok:
    s_or_b32 s95, s2, s3
    s_cmp_eq_u32 s95, 0
    s_cselect_b64 s[0:1], -1, 0
    v_lshlrev_b32 v25, 5, v1
    v_mfma_f32_32x32x16_bf16 a[240:255], a[148:151], v[68:71], a[240:255]
    ds_read_b64_tr_b16 a[92:93], v16 offset:6144
    ds_read_b64_tr_b16 a[94:95], v16 offset:7168
    buffer_load_dwordx4 v[132:135], v4, s[48:51], s98 offen offset:0 sc1
    v_mov_b32 v26, 1073741824
    v_cndmask_b32 v2, v26, v25, s[0:1]
    v_mfma_f32_32x32x16_bf16 a[192:207], a[152:155], v[72:75], a[192:207]
    ds_read_b64_tr_b16 a[96:97], v9 offset:8192
    ds_read_b64_tr_b16 a[98:99], v9 offset:9216
    buffer_load_dwordx4 v[136:139], v3, s[48:51], s98 offen offset:1024 sc1
    s_mov_b32 s95, 0
    buffer_load_dword v25, v2, s[48:51], s95 offen sc1
    v_mfma_f32_32x32x16_bf16 a[208:223], a[156:159], v[72:75], a[208:223]
    ds_read_b64_tr_b16 a[100:101], v10 offset:8192
    ds_read_b64_tr_b16 a[102:103], v10 offset:9216
    buffer_load_dwordx4 v[140:143], v4, s[48:51], s98 offen offset:1024 sc1
    s_mov_b32 s95, 32768
    buffer_load_dword v26, v2, s[48:51], s95 offen sc1
    v_mfma_f32_32x32x16_bf16 a[224:239], a[152:155], v[76:79], a[224:239]
    ds_read_b64_tr_b16 a[104:105], v9 offset:10240
    ds_read_b64_tr_b16 a[106:107], v9 offset:11264
    s_mov_b32 s95, 65536
    buffer_load_dword v27, v2, s[48:51], s95 offen sc1
    v_mfma_f32_32x32x16_bf16 a[240:255], a[156:159], v[76:79], a[240:255]
    ds_read_b64_tr_b16 a[108:109], v10 offset:10240
    ds_read_b64_tr_b16 a[110:111], v10 offset:11264
    s_add_u32 s98, s100, s47
    buffer_load_dwordx4 v[144:147], v3, s[48:51], s98 offen offset:0 sc1
    s_mov_b32 s95, 98304
    buffer_load_dword v28, v2, s[48:51], s95 offen sc1
    v_mfma_f32_32x32x16_bf16 a[192:207], a[160:163], v[80:83], a[192:207]
    ds_read_b64_tr_b16 a[112:113], v9 offset:12288
    ds_read_b64_tr_b16 a[114:115], v9 offset:13312
    buffer_load_dwordx4 v[148:151], v4, s[48:51], s98 offen offset:0 sc1
    v_mfma_f32_32x32x16_bf16 a[208:223], a[164:167], v[80:83], a[208:223]
    ds_read_b64_tr_b16 a[116:117], v10 offset:12288
    ds_read_b64_tr_b16 a[118:119], v10 offset:13312
    buffer_load_dwordx4 v[152:155], v3, s[48:51], s98 offen offset:1024 sc1
    v_mfma_f32_32x32x16_bf16 a[224:239], a[160:163], v[84:87], a[224:239]
    ds_read_b64_tr_b16 a[120:121], v9 offset:14336
    ds_read_b64_tr_b16 a[122:123], v9 offset:15360
    buffer_load_dwordx4 v[156:159], v4, s[48:51], s98 offen offset:1024 sc1
    v_mfma_f32_32x32x16_bf16 a[240:255], a[164:167], v[84:87], a[240:255]
    ds_read_b64_tr_b16 a[124:125], v10 offset:14336
    ds_read_b64_tr_b16 a[126:127], v10 offset:15360
    v_mfma_f32_32x32x16_bf16 a[192:207], a[168:171], v[88:91], a[192:207]
    buffer_load_dwordx4 v[160:163], v3, s[48:51], s72 offen offset:0 sc1
    s_barrier
    v_mfma_f32_32x32x16_bf16 a[208:223], a[172:175], v[88:91], a[208:223]
    buffer_load_dwordx4 v[164:167], v4, s[48:51], s72 offen offset:0 sc1
    s_waitcnt vmcnt(27)
    v_mfma_f32_32x32x16_bf16 a[224:239], a[168:171], v[92:95], a[224:239]
    buffer_load_dwordx4 v[168:171], v3, s[48:51], s72 offen offset:2048 sc1
    v_mfma_f32_32x32x16_bf16 a[240:255], a[172:175], v[92:95], a[240:255]
    buffer_load_dwordx4 v[172:175], v4, s[48:51], s72 offen offset:2048 sc1
    s_waitcnt vmcnt(27)
    v_mfma_f32_32x32x16_bf16 a[192:207], a[176:179], v[32:35], a[192:207]
    v_mfma_f32_32x32x16_bf16 a[208:223], a[180:183], v[32:35], a[208:223]
    buffer_load_dwordx4 v[176:179], v3, s[48:51], s73 offen offset:0 sc1
    s_waitcnt vmcnt(27)
    v_mfma_f32_32x32x16_bf16 a[224:239], a[176:179], v[36:39], a[224:239]
    v_mfma_f32_32x32x16_bf16 a[240:255], a[180:183], v[36:39], a[240:255]
    buffer_load_dwordx4 v[180:183], v4, s[48:51], s73 offen offset:0 sc1
    s_waitcnt vmcnt(27)
    v_mfma_f32_32x32x16_bf16 a[192:207], a[184:187], v[40:43], a[192:207]
    buffer_load_dwordx4 v[184:187], v3, s[48:51], s73 offen offset:2048 sc1
    v_mfma_f32_32x32x16_bf16 a[208:223], a[188:191], v[40:43], a[208:223]
    buffer_load_dwordx4 v[188:191], v4, s[48:51], s73 offen offset:2048 sc1
    s_waitcnt vmcnt(28)
    v_mfma_f32_32x32x16_bf16 a[224:239], a[184:187], v[44:47], a[224:239]
    v_mfma_f32_32x32x16_bf16 a[240:255], a[188:191], v[44:47], a[240:255]
    buffer_load_dwordx4 v[192:195], v3, s[48:51], s74 offen offset:0 sc1
    s_waitcnt vmcnt(28)
    v_mfma_f32_32x32x16_bf16 a[208:223], a[36:39], v[96:99], a[208:223]
    s_waitcnt vmcnt(27)
    v_mfma_f32_32x32x16_bf16 a[224:239], a[32:35], v[100:103], a[224:239]
    buffer_load_dwordx4 v[196:199], v4, s[48:51], s74 offen offset:0 sc1
    v_mfma_f32_32x32x16_bf16 a[240:255], a[36:39], v[100:103], a[240:255]
    buffer_load_dwordx4 v[200:203], v3, s[48:51], s74 offen offset:2048 sc1
    s_waitcnt vmcnt(28)
    v_mfma_f32_32x32x16_bf16 a[208:223], a[44:47], v[104:107], a[208:223]
    buffer_load_dwordx4 v[204:207], v4, s[48:51], s74 offen offset:2048 sc1
    s_waitcnt vmcnt(28)
    v_mfma_f32_32x32x16_bf16 a[224:239], a[40:43], v[108:111], a[224:239]
    v_mfma_f32_32x32x16_bf16 a[240:255], a[44:47], v[108:111], a[240:255]
    buffer_load_dwordx4 v[208:211], v3, s[48:51], s75 offen offset:0 sc1
    s_waitcnt vmcnt(28)
    v_mfma_f32_32x32x16_bf16 a[208:223], a[52:55], v[112:115], a[208:223]
    s_waitcnt vmcnt(27)
    v_mfma_f32_32x32x16_bf16 a[224:239], a[48:51], v[116:119], a[224:239]
    buffer_load_dwordx4 v[212:215], v4, s[48:51], s75 offen offset:0 sc1
    v_mfma_f32_32x32x16_bf16 a[240:255], a[52:55], v[116:119], a[240:255]
    buffer_load_dwordx4 v[216:219], v3, s[48:51], s75 offen offset:2048 sc1
    s_waitcnt vmcnt(18)
    v_xor_b32 v25, s83, v25
    v_xor_b32 v26, s83, v26
    v_xor_b32 v27, s83, v27
    v_xor_b32 v28, s83, v28
    v_mov_b32 v23, s83
    buffer_store_dword v23, v19, s[48:51], 0 offen offset:12 sc1
    v_mfma_f32_32x32x16_bf16 a[208:223], a[60:63], v[120:123], a[208:223]
    buffer_load_dwordx4 v[220:223], v4, s[48:51], s75 offen offset:2048 sc1
    v_or3_b32 v25, v25, v26, v27
    v_or_b32 v25, v25, v28
    v_cmp_ne_u32 vcc, 0, v25
    v_mov_b32 v23, s83
    s_and_b64 vcc, vcc, s[0:1]
    s_mov_b32 s95, 131072
    s_cbranch_vccnz L_gen_slow
L_gen_ok:
    v_or_b32 v25, v2, v19
    buffer_store_dword v23, v25, s[48:51], s95 offen sc1
    v_mfma_f32_32x32x16_bf16 a[224:239], a[56:59], v[124:127], a[224:239]
    v_mfma_f32_32x32x16_bf16 a[240:255], a[60:63], v[124:127], a[240:255]
    v_mfma_f32_32x32x16_bf16 a[208:223], a[68:71], v[128:131], a[208:223]
    v_mfma_f32_32x32x16_bf16 a[224:239], a[64:67], v[132:135], a[224:239]
    v_mfma_f32_32x32x16_bf16 a[240:255], a[68:71], v[132:135], a[240:255]
    v_mfma_f32_32x32x16_bf16 a[208:223], a[76:79], v[136:139], a[208:223]
    v_bfe_u32 v24, v1, 4, 5
    v_bfe_u32 v25, v1, 9, 1
    v_lshlrev_b32 v24, 10, v24
    v_lshl_add_u32 v26, v25, 3, v24
    v_lshl_add_u32 v24, v25, 4, v24
    v_mfma_f32_32x32x16_bf16 a[224:239], a[72:75], v[140:143], a[224:239]
    v_mfma_f32_32x32x16_bf16 a[240:255], a[76:79], v[140:143], a[240:255]
    s_waitcnt lgkmcnt(15)
    v_mfma_f32_32x32x16_bf16 a[208:223], a[84:87], v[144:147], a[208:223]
    buffer_load_dwordx2 v[248:249], v26, s[24:27], s90 offen offset:0
    s_waitcnt vmcnt(21)
    v_mfma_f32_32x32x16_bf16 a[224:239], a[80:83], v[148:151], a[224:239]
    v_mfma_f32_32x32x16_bf16 a[240:255], a[84:87], v[148:151], a[240:255]
    buffer_load_dwordx2 v[250:251], v26, s[24:27], s90 offen offset:16
    s_waitcnt vmcnt(21)
    v_mfma_f32_32x32x16_bf16 a[208:223], a[92:95], v[152:155], a[208:223]
    s_waitcnt vmcnt(20)
    v_mfma_f32_32x32x16_bf16 a[224:239], a[88:91], v[156:159], a[224:239]
    buffer_load_dwordx2 v[252:253], v26, s[24:27], s90 offen offset:32
    v_mfma_f32_32x32x16_bf16 a[240:255], a[92:95], v[156:159], a[240:255]
    s_waitcnt vmcnt(20)
    v_mfma_f32_32x32x16_bf16 a[208:223], a[4:7], v[160:163], a[208:223]
    buffer_load_dwordx2 v[254:255], v26, s[24:27], s90 offen offset:48
    s_waitcnt vmcnt(20)
    v_mfma_f32_32x32x16_bf16 a[224:239], a[0:3], v[164:167], a[224:239]
    v_mfma_f32_32x32x16_bf16 a[240:255], a[4:7], v[164:167], a[240:255]
    s_waitcnt vmcnt(19)
    v_mfma_f32_32x32x16_bf16 a[208:223], a[12:15], v[168:171], a[208:223]
    s_xor_b32 s95, s3, 1
    s_waitcnt vmcnt(18)
    v_mfma_f32_32x32x16_bf16 a[224:239], a[8:11], v[172:175], a[224:239]
    s_mul_i32 s95, s95, 12288
    s_add_u32 s95, s95, 65536
    v_mfma_f32_32x32x16_bf16 a[240:255], a[12:15], v[172:175], a[240:255]
    v_add_u32 v6, s95, v1
    s_waitcnt vmcnt(17)
    v_mfma_f32_32x32x16_bf16 a[208:223], a[20:23], v[176:179], a[208:223]
    s_xor_b32 s95, s3, 2
    s_waitcnt vmcnt(16)
    v_mfma_f32_32x32x16_bf16 a[224:239], a[16:19], v[180:183], a[224:239]
    s_mul_i32 s95, s95, 12288
    v_mfma_f32_32x32x16_bf16 a[240:255], a[20:23], v[180:183], a[240:255]
    s_add_u32 s95, s95, 69632
    s_waitcnt vmcnt(15)
    v_mfma_f32_32x32x16_bf16 a[208:223], a[28:31], v[184:187], a[208:223]
    v_add_u32 v7, s95, v1
    s_xor_b32 s95, s3, 3
    s_waitcnt vmcnt(14)
    v_mfma_f32_32x32x16_bf16 a[224:239], a[24:27], v[188:191], a[224:239]
    s_mul_i32 s95, s95, 12288
    v_mfma_f32_32x32x16_bf16 a[240:255], a[28:31], v[188:191], a[240:255]
    s_waitcnt vmcnt(10)
    v_max3_u32 v23, v192, v196, v200
    v_max_u32 v23, v23, v204
    v_cmp_eq_u32 vcc, -1, v23
    s_nop 0
    s_cbranch_vccnz L_c16_slow
L_c16_ok:
    s_waitcnt lgkmcnt(8)
    v_mfma_f32_32x32x16_bf16 a[208:223], a[100:103], v[192:195], a[208:223]
    s_add_u32 s95, s95, 73728
    v_mfma_f32_32x32x16_bf16 a[224:239], a[96:99], v[196:199], a[224:239]
    v_add_u32 v8, s95, v1
    s_mul_i32 s95, s3, 12288
    v_mfma_f32_32x32x16_bf16 a[240:255], a[100:103], v[196:199], a[240:255]
    s_add_u32 s95, s95, 65536
    v_mfma_f32_32x32x16_bf16 a[208:223], a[108:111], v[200:203], a[208:223]
    v_add_u32 v5, s95, v1
    v_mfma_f32_32x32x16_bf16 a[224:239], a[104:107], v[204:207], a[224:239]
    s_waitcnt vmcnt(0)
    v_mfma_f32_32x32x16_bf16 a[240:255], a[108:111], v[204:207], a[240:255]
    v_max3_u32 v23, v208, v212, v216
    v_max_u32 v23, v23, v220
    v_cmp_eq_u32 vcc, -1, v23
    s_nop 0
    s_cbranch_vccnz L_c17_slow
L_c17_ok:
    s_waitcnt lgkmcnt(0)
    v_mfma_f32_32x32x16_bf16 a[208:223], a[116:119], v[208:211], a[208:223]
    v_lshlrev_b32 v224, 16, v248
    v_mfma_f32_32x32x16_bf16 a[224:239], a[112:115], v[212:215], a[224:239]
    v_and_b32 v225, s85, v248
    v_mfma_f32_32x32x16_bf16 a[240:255], a[116:119], v[212:215], a[240:255]
    v_mfma_f32_32x32x16_bf16 a[208:223], a[124:127], v[216:219], a[208:223]
    v_lshlrev_b32 v226, 16, v249
    v_mfma_f32_32x32x16_bf16 a[224:239], a[120:123], v[220:223], a[224:239]
    v_and_b32 v227, s85, v249
    v_mfma_f32_32x32x16_bf16 a[240:255], a[124:127], v[220:223], a[240:255]
    v_mfma_f32_32x32x16_bf16 a[192:207], a[32:35], v[96:99], a[192:207]
    s_nop 7
    v_lshlrev_b32 v228, 16, v250
    v_mfma_f32_32x32x16_bf16 a[192:207], a[40:43], v[104:107], a[192:207]
    ds_write_b128 v6, a[208:211] offset:0
    v_and_b32 v229, s85, v250
    v_mfma_f32_32x32x16_bf16 a[192:207], a[48:51], v[112:115], a[192:207]
    ds_write_b128 v6, a[212:215] offset:1024
    v_mfma_f32_32x32x16_bf16 a[192:207], a[56:59], v[120:123], a[192:207]
    ds_write_b128 v6, a[216:219] offset:2048
    v_lshlrev_b32 v230, 16, v251
    v_mfma_f32_32x32x16_bf16 a[192:207], a[64:67], v[128:131], a[192:207]
    ds_write_b128 v6, a[220:223] offset:3072
    v_and_b32 v231, s85, v251
    v_mfma_f32_32x32x16_bf16 a[192:207], a[72:75], v[136:139], a[192:207]
    ds_write_b128 v7, a[224:227] offset:0
    v_lshlrev_b32 v232, 16, v252
    v_mfma_f32_32x32x16_bf16 a[192:207], a[80:83], v[144:147], a[192:207]
    ds_write_b128 v7, a[228:231] offset:1024
    v_mfma_f32_32x32x16_bf16 a[192:207], a[88:91], v[152:155], a[192:207]
    v_and_b32 v233, s85, v252
    v_mfma_f32_32x32x16_bf16 a[192:207], a[0:3], v[160:163], a[192:207]
    ds_write_b128 v7, a[232:235] offset:2048
    v_lshlrev_b32 v234, 16, v253
    v_mfma_f32_32x32x16_bf16 a[192:207], a[8:11], v[168:171], a[192:207]
    ds_write_b128 v7, a[236:239] offset:3072
    v_and_b32 v235, s85, v253
    v_mfma_f32_32x32x16_bf16 a[192:207], a[16:19], v[176:179], a[192:207]
    ds_write_b128 v8, a[240:243] offset:0
    v_mfma_f32_32x32x16_bf16 a[192:207], a[24:27], v[184:187], a[192:207]
    ds_write_b128 v8, a[244:247] offset:1024
    v_lshlrev_b32 v236, 16, v254
    v_mfma_f32_32x32x16_bf16 a[192:207], a[96:99], v[192:195], a[192:207]
    ds_write_b128 v8, a[248:251] offset:2048
    v_and_b32 v237, s85, v254
    v_mfma_f32_32x32x16_bf16 a[192:207], a[104:107], v[200:203], a[192:207]
    ds_write_b128 v8, a[252:255] offset:3072
    v_lshlrev_b32 v238, 16, v255
    v_mfma_f32_32x32x16_bf16 a[192:207], a[112:115], v[208:211], a[192:207]
    v_mfma_f32_32x32x16_bf16 a[192:207], a[120:123], v[216:219], a[192:207]
    v_and_b32 v239, s85, v255
    s_nop 11
    v_accvgpr_read_b32 v176, a192
    v_accvgpr_read_b32 v177, a193
    v_accvgpr_read_b32 v178, a194
    v_accvgpr_read_b32 v179, a195
    v_accvgpr_read_b32 v180, a196
    v_accvgpr_read_b32 v181, a197
    v_accvgpr_read_b32 v182, a198
    v_accvgpr_read_b32 v183, a199
    v_accvgpr_read_b32 v184, a200
    v_accvgpr_read_b32 v185, a201
    v_accvgpr_read_b32 v186, a202
    v_accvgpr_read_b32 v187, a203
    v_accvgpr_read_b32 v188, a204
    v_accvgpr_read_b32 v189, a205
    v_accvgpr_read_b32 v190, a206
    v_accvgpr_read_b32 v191, a207
    v_pk_add_f32 v[176:177], v[176:177], v[224:225]
    v_pk_add_f32 v[178:179], v[178:179], v[226:227]
    v_pk_add_f32 v[180:181], v[180:181], v[228:229]
    v_pk_add_f32 v[182:183], v[182:183], v[230:231]
    v_pk_add_f32 v[184:185], v[184:185], v[232:233]
    v_pk_add_f32 v[186:187], v[186:187], v[234:235]
    v_pk_add_f32 v[188:189], v[188:189], v[236:237]
    v_pk_add_f32 v[190:191], v[190:191], v[238:239]
    s_waitcnt lgkmcnt(0)
    s_barrier
    ds_read_b128 v[128:131], v5 offset:0
    ds_read_b128 v[132:135], v5 offset:1024
    ds_read_b128 v[136:139], v5 offset:2048
    ds_read_b128 v[140:143], v5 offset:3072
    ds_read_b128 v[144:147], v5 offset:4096
    ds_read_b128 v[148:151], v5 offset:5120
    ds_read_b128 v[152:155], v5 offset:6144
    ds_read_b128 v[156:159], v5 offset:7168
    ds_read_b128 v[160:163], v5 offset:8192
    ds_read_b128 v[164:167], v5 offset:9216
    ds_read_b128 v[168:171], v5 offset:10240
    ds_read_b128 v[172:175], v5 offset:11264
    s_waitcnt lgkmcnt(8)
    v_pk_add_f32 v[176:177], v[176:177], v[128:129]
    v_pk_add_f32 v[178:179], v[178:179], v[130:131]
    v_pk_add_f32 v[180:181], v[180:181], v[132:133]
    v_pk_add_f32 v[182:183], v[182:183], v[134:135]
    v_pk_add_f32 v[184:185], v[184:185], v[136:137]
    v_pk_add_f32 v[186:187], v[186:187], v[138:139]
    v_pk_add_f32 v[188:189], v[188:189], v[140:141]
    v_pk_add_f32 v[190:191], v[190:191], v[142:143]
    s_waitcnt lgkmcnt(4)
    v_pk_add_f32 v[176:177], v[176:177], v[144:145]
    v_pk_add_f32 v[178:179], v[178:179], v[146:147]
    v_pk_add_f32 v[180:181], v[180:181], v[148:149]
    v_pk_add_f32 v[182:183], v[182:183], v[150:151]
    v_pk_add_f32 v[184:185], v[184:185], v[152:153]
    v_pk_add_f32 v[186:187], v[186:187], v[154:155]
    v_pk_add_f32 v[188:189], v[188:189], v[156:157]
    v_pk_add_f32 v[190:191], v[190:191], v[158:159]
    s_waitcnt lgkmcnt(0)
    v_pk_add_f32 v[176:177], v[176:177], v[160:161]
    v_pk_add_f32 v[178:179], v[178:179], v[162:163]
    v_pk_add_f32 v[180:181], v[180:181], v[164:165]
    v_pk_add_f32 v[182:183], v[182:183], v[166:167]
    v_pk_add_f32 v[184:185], v[184:185], v[168:169]
    v_pk_add_f32 v[186:187], v[186:187], v[170:171]
    v_pk_add_f32 v[188:189], v[188:189], v[172:173]
    v_pk_add_f32 v[190:191], v[190:191], v[174:175]
    v_cvt_pk_bf16_f32 v192, v176, v177
    v_cvt_pk_bf16_f32 v193, v178, v179
    v_cvt_pk_bf16_f32 v194, v180, v181
    v_cvt_pk_bf16_f32 v195, v182, v183
    v_cvt_pk_bf16_f32 v196, v184, v185
    v_cvt_pk_bf16_f32 v197, v186, v187
    v_cvt_pk_bf16_f32 v198, v188, v189
    v_cvt_pk_bf16_f32 v199, v190, v191
    s_nop 0
    v_permlane32_swap_b32 v192, v194
    v_permlane32_swap_b32 v193, v195
    v_permlane32_swap_b32 v196, v198
    v_permlane32_swap_b32 v197, v199
    buffer_store_dwordx4 v[192:195], v24, s[64:67], s90 offen offset:0 nt
    buffer_store_dwordx4 v[196:199], v24, s[64:67], s90 offen offset:32 nt
    s_endpgm
L_ps_slow:
    s_mov_b32 s95, 0x40000
L_ps_loop:
    buffer_load_dwordx4 v[56:59], v55, s[48:51], s10 offen offset:0 sc1
    buffer_load_dwordx4 v[60:63], v55, s[48:51], s10 offen offset:512 sc1
    s_sub_u32 s95, s95, 1
    s_cbranch_scc1 L_ps_ok
    s_waitcnt vmcnt(0)
    v_cmp_ne_u32 s[96:97], s83, v58
    v_cmp_ne_u32 vcc, s83, v62
    s_nop 0
    s_or_b64 vcc, vcc, s[96:97]
    s_cbranch_vccnz L_ps_loop
    s_branch L_ps_ok
L_p1_slow:
    s_mov_b32 s97, 0x40000
L_p1_loop:
    buffer_load_dword v30, v22, s[48:51], 0 offen offset:0 sc1
    s_sub_u32 s97, s97, 1
    s_cbranch_scc1 L_p1_ok
    s_waitcnt vmcnt(0)
    v_cmp_ne_u32 vcc, s83, v30
    s_nop 0
    s_and_b64 vcc, vcc, s[0:1]
    s_cbranch_vccnz L_p1_loop
    s_branch L_p1_ok
L_pE_slow:
    s_mov_b32 s97, 0x40000
L_pE_loop:
    buffer_load_dword v30, v22, s[48:51], 0 offen offset:20 sc1
    s_sub_u32 s97, s97, 1
    s_cbranch_scc1 L_pE_ok
    s_waitcnt vmcnt(0)
    v_cmp_ne_u32 vcc, s83, v30
    s_nop 0
    s_and_b32 vcc_lo, vcc_lo, 0x7f80
    s_mov_b32 vcc_hi, 0
    s_cbranch_vccnz L_pE_loop
    s_branch L_pE_ok
L_f0_slow:
    s_waitcnt lgkmcnt(0)
    s_nop 15
    s_lshl2_add_u32 s91, s79, s3
    s_sub_i32 s91, 8, s91
    s_max_i32 s91, s91, 0
    v_mov_b32 v24, 0xff800000
    v_mov_b32 v26, 0xff800000
    v_sub_u32 v232, v232, v237
    v_sub_u32 v233, v233, v237
    v_sub_u32 v234, v234, v237
    v_sub_u32 v235, v235, v237
    s_mov_b32 s95, s91
L_f0_l0:
    s_mul_i32 s96, s95, 4160
    v_add_u32 v25, s96, v236
    ds_read_b128 v[136:139], v25 offset:0
    s_waitcnt lgkmcnt(0)
    v_mfma_f32_32x32x16_bf16 v[160:175], v[136:139], v[128:131], 0
    s_nop 15
    s_nop 3
    s_cmp_lg_u32 s95, 8
    s_cbranch_scc1 L_f0_a0
    v_cndmask_b32 v160, v26, v160, s[4:5]
    v_cndmask_b32 v161, v26, v161, s[6:7]
    v_cndmask_b32 v162, v26, v162, s[8:9]
    v_cndmask_b32 v163, v26, v163, s[10:11]
    v_cndmask_b32 v164, v26, v164, s[12:13]
    v_cndmask_b32 v165, v26, v165, s[14:15]
    v_cndmask_b32 v166, v26, v166, s[16:17]
    v_cndmask_b32 v167, v26, v167, s[18:19]
    v_cndmask_b32 v168, v26, v168, s[20:21]
    v_cndmask_b32 v169, v26, v169, s[22:23]
    v_cndmask_b32 v170, v26, v170, s[28:29]
    v_cndmask_b32 v171, v26, v171, s[30:31]
    v_cndmask_b32 v172, v26, v172, s[32:33]
    v_cndmask_b32 v173, v26, v173, s[34:35]
    v_cndmask_b32 v174, v26, v174, s[36:37]
    v_cndmask_b32 v175, v26, v175, s[38:39]
L_f0_a0:
    s_cmp_lg_u32 s95, 0
    s_cbranch_scc1 L_f0_b0
    v_cndmask_b32 v160, v160, v26, s[4:5]
    v_cndmask_b32 v161, v161, v26, s[6:7]
    v_cndmask_b32 v162, v162, v26, s[8:9]
    v_cndmask_b32 v163, v163, v26, s[10:11]
    v_cndmask_b32 v164, v164, v26, s[12:13]
    v_cndmask_b32 v165, v165, v26, s[14:15]
    v_cndmask_b32 v166, v166, v26, s[16:17]
    v_cndmask_b32 v167, v167, v26, s[18:19]
    v_cndmask_b32 v168, v168, v26, s[20:21]
    v_cndmask_b32 v169, v169, v26, s[22:23]
    v_cndmask_b32 v170, v170, v26, s[28:29]
    v_cndmask_b32 v171, v171, v26, s[30:31]
    v_cndmask_b32 v172, v172, v26, s[32:33]
    v_cndmask_b32 v173, v173, v26, s[34:35]
    v_cndmask_b32 v174, v174, v26, s[36:37]
    v_cndmask_b32 v175, v175, v26, s[38:39]
L_f0_b0:
    v_max3_f32 v24, v24, v160, v161
    v_max3_f32 v24, v24, v162, v163
    v_max3_f32 v24, v24, v164, v165
    v_max3_f32 v24, v24, v166, v167
    v_max3_f32 v24, v24, v168, v169
    v_max3_f32 v24, v24, v170, v171
    v_max3_f32 v24, v24, v172, v173
    v_max3_f32 v24, v24, v174, v175
    s_add_u32 s95, s95, 1
    s_cmp_le_u32 s95, 8
    s_cbranch_scc1 L_f0_l0
    v_mov_b32 v25, v24
    s_nop 1
    v_permlane32_swap_b32 v24, v25
    s_nop 1
    v_max_f32 v24, v24, v25
    v_mov_b32 v208, 0
    v_mov_b32 v209, 0
    v_mov_b32 v210, 0
    v_mov_b32 v211, 0
    v_mov_b32 v212, 0
    v_mov_b32 v213, 0
    v_mov_b32 v214, 0
    v_mov_b32 v215, 0
    v_mov_b32 v216, 0
    v_mov_b32 v217, 0
    v_mov_b32 v218, 0
    v_mov_b32 v219, 0
    v_mov_b32 v220, 0
    v_mov_b32 v221, 0
    v_mov_b32 v222, 0
    v_mov_b32 v223, 0
    s_mov_b32 s95, s91
L_f0_l1:
    s_mul_i32 s96, s95, 4160
    v_add_u32 v25, s96, v236
    ds_read_b128 v[136:139], v25 offset:0
    v_add_u32 v25, s96, v232
    ds_read_b64_tr_b16 v[240:241], v25
    v_add_u32 v25, s96, v233
    ds_read_b64_tr_b16 v[242:243], v25
    v_add_u32 v25, s96, v234
    ds_read_b64_tr_b16 v[244:245], v25
    v_add_u32 v25, s96, v235
    ds_read_b64_tr_b16 v[246:247], v25
    s_waitcnt lgkmcnt(0)
    v_mfma_f32_32x32x16_bf16 v[160:175], v[136:139], v[128:131], 0
    s_nop 15
    s_nop 3
    s_cmp_lg_u32 s95, 8
    s_cbranch_scc1 L_f0_a1
    v_cndmask_b32 v160, v26, v160, s[4:5]
    v_cndmask_b32 v161, v26, v161, s[6:7]
    v_cndmask_b32 v162, v26, v162, s[8:9]
    v_cndmask_b32 v163, v26, v163, s[10:11]
    v_cndmask_b32 v164, v26, v164, s[12:13]
    v_cndmask_b32 v165, v26, v165, s[14:15]
    v_cndmask_b32 v166, v26, v166, s[16:17]
    v_cndmask_b32 v167, v26, v167, s[18:19]
    v_cndmask_b32 v168, v26, v168, s[20:21]
    v_cndmask_b32 v169, v26, v169, s[22:23]
    v_cndmask_b32 v170, v26, v170, s[28:29]
    v_cndmask_b32 v171, v26, v171, s[30:31]
    v_cndmask_b32 v172, v26, v172, s[32:33]
    v_cndmask_b32 v173, v26, v173, s[34:35]
    v_cndmask_b32 v174, v26, v174, s[36:37]
    v_cndmask_b32 v175, v26, v175, s[38:39]
L_f0_a1:
    s_cmp_lg_u32 s95, 0
    s_cbranch_scc1 L_f0_b1
    v_cndmask_b32 v160, v160, v26, s[4:5]
    v_cndmask_b32 v161, v161, v26, s[6:7]
    v_cndmask_b32 v162, v162, v26, s[8:9]
    v_cndmask_b32 v163, v163, v26, s[10:11]
    v_cndmask_b32 v164, v164, v26, s[12:13]
    v_cndmask_b32 v165, v165, v26, s[14:15]
    v_cndmask_b32 v166, v166, v26, s[16:17]
    v_cndmask_b32 v167, v167, v26, s[18:19]
    v_cndmask_b32 v168, v168, v26, s[20:21]
    v_cndmask_b32 v169, v169, v26, s[22:23]
    v_cndmask_b32 v170, v170, v26, s[28:29]
    v_cndmask_b32 v171, v171, v26, s[30:31]
    v_cndmask_b32 v172, v172, v26, s[32:33]
    v_cndmask_b32 v173, v173, v26, s[34:35]
    v_cndmask_b32 v174, v174, v26, s[36:37]
    v_cndmask_b32 v175, v175, v26, s[38:39]
L_f0_b1:
    v_sub_f32 v160, v160, v24
    v_sub_f32 v161, v161, v24
    v_sub_f32 v162, v162, v24
    v_sub_f32 v163, v163, v24
    v_sub_f32 v164, v164, v24
    v_sub_f32 v165, v165, v24
    v_sub_f32 v166, v166, v24
    v_sub_f32 v167, v167, v24
    v_sub_f32 v168, v168, v24
    v_sub_f32 v169, v169, v24
    v_sub_f32 v170, v170, v24
    v_sub_f32 v171, v171, v24
    v_sub_f32 v172, v172, v24
    v_sub_f32 v173, v173, v24
    v_sub_f32 v174, v174, v24
    v_sub_f32 v175, v175, v24
    v_exp_f32 v160, v160
    v_exp_f32 v161, v161
    v_exp_f32 v162, v162
    v_exp_f32 v163, v163
    v_exp_f32 v164, v164
    v_exp_f32 v165, v165
    v_exp_f32 v166, v166
    v_exp_f32 v167, v167
    v_exp_f32 v168, v168
    v_exp_f32 v169, v169
    v_exp_f32 v170, v170
    v_exp_f32 v171, v171
    v_exp_f32 v172, v172
    v_exp_f32 v173, v173
    v_exp_f32 v174, v174
    v_exp_f32 v175, v175
    s_nop 0
    v_cvt_pk_bf16_f32 v144, v160, v161
    v_cvt_pk_bf16_f32 v145, v162, v163
    v_cvt_pk_bf16_f32 v146, v164, v165
    v_cvt_pk_bf16_f32 v147, v166, v167
    v_cvt_pk_bf16_f32 v148, v168, v169
    v_cvt_pk_bf16_f32 v149, v170, v171
    v_cvt_pk_bf16_f32 v150, v172, v173
    v_cvt_pk_bf16_f32 v151, v174, v175
    s_nop 1
    v_mfma_f32_32x32x16_bf16 v[208:223], v[240:243], v[144:147], v[208:223]
    v_mfma_f32_32x32x16_bf16 v[208:223], v[244:247], v[148:151], v[208:223]
    s_nop 15
    s_nop 3
    s_add_u32 s95, s95, 1
    s_cmp_le_u32 s95, 8
    s_cbranch_scc1 L_f0_l1
    v_add_u32 v232, v232, v237
    v_add_u32 v233, v233, v237
    v_add_u32 v234, v234, v237
    v_add_u32 v235, v235, v237
    ds_read_b128 v[136:139], v236 offset:34304
    ds_read_b128 v[140:143], v236 offset:1024
    ds_read_b64_tr_b16 v[240:241], v232 offset:33280
    ds_read_b64_tr_b16 v[242:243], v233 offset:33280
    ds_read_b64_tr_b16 v[244:245], v234 offset:33280
    ds_read_b64_tr_b16 v[246:247], v235 offset:33280
    s_waitcnt lgkmcnt(0)
    v_mfma_f32_32x32x16_bf16 v[160:175], v[136:139], v[132:135], 0
    v_mfma_f32_32x32x16_bf16 v[192:207], v[140:143], v[132:135], 0
    ds_read_b128 v[136:139], v236 offset:5184
    s_waitcnt lgkmcnt(0)
    s_nop 15
    s_nop 3
    v_cndmask_b32 v160, v192, v160, s[4:5]
    v_cndmask_b32 v161, v193, v161, s[6:7]
    v_cndmask_b32 v162, v194, v162, s[8:9]
    v_cndmask_b32 v163, v195, v163, s[10:11]
    v_cndmask_b32 v164, v196, v164, s[12:13]
    v_cndmask_b32 v165, v197, v165, s[14:15]
    v_cndmask_b32 v166, v198, v166, s[16:17]
    v_cndmask_b32 v167, v199, v167, s[18:19]
    v_cndmask_b32 v168, v200, v168, s[20:21]
    v_cndmask_b32 v169, v201, v169, s[22:23]
    v_cndmask_b32 v170, v202, v170, s[28:29]
    v_cndmask_b32 v171, v203, v171, s[30:31]
    v_cndmask_b32 v172, v204, v172, s[32:33]
    v_cndmask_b32 v173, v205, v173, s[34:35]
    v_cndmask_b32 v174, v206, v174, s[36:37]
    v_cndmask_b32 v175, v207, v175, s[38:39]
    v_rcp_f32 v24, v216
    s_branch L_f0_ok
L_pH_slow:
    s_mov_b32 s97, 0x40000
L_pH_loop:
    buffer_load_dword v30, v238, s[48:51], 0 offen offset:4 sc1
    s_sub_u32 s97, s97, 1
    s_cbranch_scc1 L_pH_ok
    s_waitcnt vmcnt(0)
    v_cmp_ne_u32 vcc, s83, v30
    s_nop 0
    s_cbranch_vccnz L_pH_loop
    s_branch L_pH_ok
L_f1_slow:
    s_waitcnt lgkmcnt(0)
    s_nop 15
    s_lshl2_add_u32 s91, s79, s3
    s_sub_i32 s91, 8, s91
    s_max_i32 s91, s91, 0
    v_mov_b32 v24, 0xff800000
    v_mov_b32 v26, 0xff800000
    s_mov_b32 s95, s91
L_f1_l0:
    s_mul_i32 s96, s95, 4160
    v_add_u32 v25, s96, v236
    ds_read_b128 v[136:139], v25 offset:1024
    s_waitcnt lgkmcnt(0)
    v_mfma_f32_32x32x16_bf16 v[160:175], v[136:139], v[132:135], 0
    s_nop 15
    s_nop 3
    s_cmp_lg_u32 s95, 8
    s_cbranch_scc1 L_f1_a0
    v_cndmask_b32 v160, v26, v160, s[4:5]
    v_cndmask_b32 v161, v26, v161, s[6:7]
    v_cndmask_b32 v162, v26, v162, s[8:9]
    v_cndmask_b32 v163, v26, v163, s[10:11]
    v_cndmask_b32 v164, v26, v164, s[12:13]
    v_cndmask_b32 v165, v26, v165, s[14:15]
    v_cndmask_b32 v166, v26, v166, s[16:17]
    v_cndmask_b32 v167, v26, v167, s[18:19]
    v_cndmask_b32 v168, v26, v168, s[20:21]
    v_cndmask_b32 v169, v26, v169, s[22:23]
    v_cndmask_b32 v170, v26, v170, s[28:29]
    v_cndmask_b32 v171, v26, v171, s[30:31]
    v_cndmask_b32 v172, v26, v172, s[32:33]
    v_cndmask_b32 v173, v26, v173, s[34:35]
    v_cndmask_b32 v174, v26, v174, s[36:37]
    v_cndmask_b32 v175, v26, v175, s[38:39]
L_f1_a0:
    s_cmp_lg_u32 s95, 0
    s_cbranch_scc1 L_f1_b0
    v_cndmask_b32 v160, v160, v26, s[4:5]
    v_cndmask_b32 v161, v161, v26, s[6:7]
    v_cndmask_b32 v162, v162, v26, s[8:9]
    v_cndmask_b32 v163, v163, v26, s[10:11]
    v_cndmask_b32 v164, v164, v26, s[12:13]
    v_cndmask_b32 v165, v165, v26, s[14:15]
    v_cndmask_b32 v166, v166, v26, s[16:17]
    v_cndmask_b32 v167, v167, v26, s[18:19]
    v_cndmask_b32 v168, v168, v26, s[20:21]
    v_cndmask_b32 v169, v169, v26, s[22:23]
    v_cndmask_b32 v170, v170, v26, s[28:29]
    v_cndmask_b32 v171, v171, v26, s[30:31]
    v_cndmask_b32 v172, v172, v26, s[32:33]
    v_cndmask_b32 v173, v173, v26, s[34:35]
    v_cndmask_b32 v174, v174, v26, s[36:37]
    v_cndmask_b32 v175, v175, v26, s[38:39]
L_f1_b0:
    v_max3_f32 v24, v24, v160, v161
    v_max3_f32 v24, v24, v162, v163
    v_max3_f32 v24, v24, v164, v165
    v_max3_f32 v24, v24, v166, v167
    v_max3_f32 v24, v24, v168, v169
    v_max3_f32 v24, v24, v170, v171
    v_max3_f32 v24, v24, v172, v173
    v_max3_f32 v24, v24, v174, v175
    s_add_u32 s95, s95, 1
    s_cmp_le_u32 s95, 8
    s_cbranch_scc1 L_f1_l0
    v_mov_b32 v25, v24
    s_nop 1
    v_permlane32_swap_b32 v24, v25
    s_nop 1
    v_max_f32 v24, v24, v25
    v_mov_b32 v208, 0
    v_mov_b32 v209, 0
    v_mov_b32 v210, 0
    v_mov_b32 v211, 0
    v_mov_b32 v212, 0
    v_mov_b32 v213, 0
    v_mov_b32 v214, 0
    v_mov_b32 v215, 0
    v_mov_b32 v216, 0
    v_mov_b32 v217, 0
    v_mov_b32 v218, 0
    v_mov_b32 v219, 0
    v_mov_b32 v220, 0
    v_mov_b32 v221, 0
    v_mov_b32 v222, 0
    v_mov_b32 v223, 0
    s_mov_b32 s95, s91
L_f1_l1:
    s_mul_i32 s96, s95, 4160
    v_add_u32 v25, s96, v236
    ds_read_b128 v[136:139], v25 offset:1024
    v_add_u32 v25, s96, v232
    ds_read_b64_tr_b16 v[240:241], v25
    v_add_u32 v25, s96, v233
    ds_read_b64_tr_b16 v[242:243], v25
    v_add_u32 v25, s96, v234
    ds_read_b64_tr_b16 v[244:245], v25
    v_add_u32 v25, s96, v235
    ds_read_b64_tr_b16 v[246:247], v25
    s_waitcnt lgkmcnt(0)
    v_mfma_f32_32x32x16_bf16 v[160:175], v[136:139], v[132:135], 0
    s_nop 15
    s_nop 3
    s_cmp_lg_u32 s95, 8
    s_cbranch_scc1 L_f1_a1
    v_cndmask_b32 v160, v26, v160, s[4:5]
    v_cndmask_b32 v161, v26, v161, s[6:7]
    v_cndmask_b32 v162, v26, v162, s[8:9]
    v_cndmask_b32 v163, v26, v163, s[10:11]
    v_cndmask_b32 v164, v26, v164, s[12:13]
    v_cndmask_b32 v165, v26, v165, s[14:15]
    v_cndmask_b32 v166, v26, v166, s[16:17]
    v_cndmask_b32 v167, v26, v167, s[18:19]
    v_cndmask_b32 v168, v26, v168, s[20:21]
    v_cndmask_b32 v169, v26, v169, s[22:23]
    v_cndmask_b32 v170, v26, v170, s[28:29]
    v_cndmask_b32 v171, v26, v171, s[30:31]
    v_cndmask_b32 v172, v26, v172, s[32:33]
    v_cndmask_b32 v173, v26, v173, s[34:35]
    v_cndmask_b32 v174, v26, v174, s[36:37]
    v_cndmask_b32 v175, v26, v175, s[38:39]
L_f1_a1:
    s_cmp_lg_u32 s95, 0
    s_cbranch_scc1 L_f1_b1
    v_cndmask_b32 v160, v160, v26, s[4:5]
    v_cndmask_b32 v161, v161, v26, s[6:7]
    v_cndmask_b32 v162, v162, v26, s[8:9]
    v_cndmask_b32 v163, v163, v26, s[10:11]
    v_cndmask_b32 v164, v164, v26, s[12:13]
    v_cndmask_b32 v165, v165, v26, s[14:15]
    v_cndmask_b32 v166, v166, v26, s[16:17]
    v_cndmask_b32 v167, v167, v26, s[18:19]
    v_cndmask_b32 v168, v168, v26, s[20:21]
    v_cndmask_b32 v169, v169, v26, s[22:23]
    v_cndmask_b32 v170, v170, v26, s[28:29]
    v_cndmask_b32 v171, v171, v26, s[30:31]
    v_cndmask_b32 v172, v172, v26, s[32:33]
    v_cndmask_b32 v173, v173, v26, s[34:35]
    v_cndmask_b32 v174, v174, v26, s[36:37]
    v_cndmask_b32 v175, v175, v26, s[38:39]
L_f1_b1:
    v_sub_f32 v160, v160, v24
    v_sub_f32 v161, v161, v24
    v_sub_f32 v162, v162, v24
    v_sub_f32 v163, v163, v24
    v_sub_f32 v164, v164, v24
    v_sub_f32 v165, v165, v24
    v_sub_f32 v166, v166, v24
    v_sub_f32 v167, v167, v24
    v_sub_f32 v168, v168, v24
    v_sub_f32 v169, v169, v24
    v_sub_f32 v170, v170, v24
    v_sub_f32 v171, v171, v24
    v_sub_f32 v172, v172, v24
    v_sub_f32 v173, v173, v24
    v_sub_f32 v174, v174, v24
    v_sub_f32 v175, v175, v24
    v_exp_f32 v160, v160
    v_exp_f32 v161, v161
    v_exp_f32 v162, v162
    v_exp_f32 v163, v163
    v_exp_f32 v164, v164
    v_exp_f32 v165, v165
    v_exp_f32 v166, v166
    v_exp_f32 v167, v167
    v_exp_f32 v168, v168
    v_exp_f32 v169, v169
    v_exp_f32 v170, v170
    v_exp_f32 v171, v171
    v_exp_f32 v172, v172
    v_exp_f32 v173, v173
    v_exp_f32 v174, v174
    v_exp_f32 v175, v175
    s_nop 0
    v_cvt_pk_bf16_f32 v144, v160, v161
    v_cvt_pk_bf16_f32 v145, v162, v163
    v_cvt_pk_bf16_f32 v146, v164, v165
    v_cvt_pk_bf16_f32 v147, v166, v167
    v_cvt_pk_bf16_f32 v148, v168, v169
    v_cvt_pk_bf16_f32 v149, v170, v171
    v_cvt_pk_bf16_f32 v150, v172, v173
    v_cvt_pk_bf16_f32 v151, v174, v175
    s_nop 1
    v_mfma_f32_32x32x16_bf16 v[208:223], v[240:243], v[144:147], v[208:223]
    v_mfma_f32_32x32x16_bf16 v[208:223], v[244:247], v[148:151], v[208:223]
    s_nop 15
    s_nop 3
    s_add_u32 s95, s95, 1
    s_cmp_le_u32 s95, 8
    s_cbranch_scc1 L_f1_l1
    s_nop 0
    v_rcp_f32 v24, v216
    s_branch L_f1_ok
L_c16_slow:
    s_mov_b32 s97, 0x40000
L_c16_loop:
    buffer_load_dword v30, v22, s[48:51], 0 offen offset:12 sc1
    buffer_load_dwordx4 v[192:195], v3, s[48:51], s74 offen offset:0 sc1
    buffer_load_dwordx4 v[196:199], v4, s[48:51], s74 offen offset:0 sc1
    buffer_load_dwordx4 v[200:203], v3, s[48:51], s74 offen offset:2048 sc1
    buffer_load_dwordx4 v[204:207], v4, s[48:51], s74 offen offset:2048 sc1
    s_waitcnt vmcnt(0)
    s_sub_u32 s97, s97, 1
    s_cbranch_scc1 L_c16_ok
    v_cmp_ne_u32 vcc, s83, v30
    s_nop 0
    s_cbranch_vccz L_c16_ok
    v_max3_u32 v23, v192, v196, v200
    v_max_u32 v23, v23, v204
    v_cmp_eq_u32 vcc, -1, v23
    s_nop 0
    s_cbranch_vccnz L_c16_loop
    s_branch L_c16_ok
L_c17_slow:
    s_mov_b32 s97, 0x40000
L_c17_loop:
    buffer_load_dword v30, v22, s[48:51], 0 offen offset:12 sc1
    buffer_load_dwordx4 v[208:211], v3, s[48:51], s75 offen offset:0 sc1
    buffer_load_dwordx4 v[212:215], v4, s[48:51], s75 offen offset:0 sc1
    buffer_load_dwordx4 v[216:219], v3, s[48:51], s75 offen offset:2048 sc1
    buffer_load_dwordx4 v[220:223], v4, s[48:51], s75 offen offset:2048 sc1
    s_waitcnt vmcnt(0)
    s_sub_u32 s97, s97, 1
    s_cbranch_scc1 L_c17_ok
    v_cmp_ne_u32 vcc, s83, v30
    s_nop 0
    s_cbranch_vccz L_c17_ok
    v_max3_u32 v23, v208, v212, v216
    v_max_u32 v23, v23, v220
    v_cmp_eq_u32 vcc, -1, v23
    s_nop 0
    s_cbranch_vccnz L_c17_loop
    s_branch L_c17_ok
L_pO_slow:
    s_mov_b32 s97, 0x40000
L_pO_loop:
    buffer_load_dword v29, v22, s[48:51], 0 offen offset:8 sc1
    s_sub_u32 s97, s97, 1
    s_cbranch_scc1 L_pO_ok
    s_waitcnt vmcnt(0)
    v_cmp_ne_u32 vcc, s83, v29
    s_nop 0
    s_cbranch_vccnz L_pO_loop
    s_branch L_pO_ok
L_gen_slow:
    s_mov_b32 s97, 0x40000
L_gen_loop:
    s_mov_b32 s96, 0
    buffer_load_dword v25, v2, s[48:51], s96 offen sc1
    s_mov_b32 s96, 32768
    buffer_load_dword v26, v2, s[48:51], s96 offen sc1
    s_mov_b32 s96, 65536
    buffer_load_dword v27, v2, s[48:51], s96 offen sc1
    s_mov_b32 s96, 98304
    buffer_load_dword v28, v2, s[48:51], s96 offen sc1
    s_sub_u32 s97, s97, 1
    s_cbranch_scc1 L_gen_ok
    s_waitcnt vmcnt(0)
    v_xor_b32 v25, s83, v25
    v_xor_b32 v26, s83, v26
    v_xor_b32 v27, s83, v27
    v_xor_b32 v28, s83, v28
    v_or3_b32 v25, v25, v26, v27
    v_or_b32 v25, v25, v28
    v_cmp_ne_u32 vcc, 0, v25
    s_nop 0
    s_cbranch_vccnz L_gen_loop
    s_branch L_gen_ok
L_end:
    s_endpgm
.section .rodata,"a"
.p2align 6
.amdhsa_kernel parallel_sum__sliding_block__swiglu_ffn__prompt_kernel
  .amdhsa_next_free_vgpr 512
  .amdhsa_next_free_sgpr 102
  .amdhsa_accum_offset 256
  .amdhsa_group_segment_fixed_size 0
  .amdhsa_kernarg_size 80
  .amdhsa_user_sgpr_count 2
  .amdhsa_user_sgpr_kernarg_segment_ptr 1
  .amdhsa_system_sgpr_workgroup_id_x 1
.end_amdhsa_kernel
```
